```python
import torch

def _softmax(x, axis=-1):
    return torch.softmax(x, dim=axis)
def _gelu(x):
    return torch.nn.functional.gelu(x, approximate="tanh")
def _silu(x):
    return torch.nn.functional.silu(x)
def _sigmoid(x):
    return torch.sigmoid(x)
def _layernorm(x, axis=-1, eps=1e-5):
    m = x.mean(dim=axis, keepdim=True)
    v = x.var(dim=axis, keepdim=True, unbiased=False)
    return (x - m) / torch.sqrt(v + eps)
def _scatter_add(tgt, idx, src, axis=0):
    return tgt.clone().index_add_(axis, idx, src)
def _segment_sum(src, seg, n):
    out = torch.zeros((n,) + src.shape[1:], dtype=src.dtype)
    return out.index_add_(0, seg, src)
def _pad(x, pw):
    flat = tuple(v for pair in reversed(pw) for v in pair)
    return torch.nn.functional.pad(x, flat)

kernel_name = 'concat_heads__linear_kernel_hedgehog__ssm_conv_s4d__prompt'

def setup_inputs():

    _w = (lambda a: (lambda t: t.to(torch.bfloat16) if t.is_floating_point() else t)(torch.as_tensor(a)))
    def _A_setup():
        B, S, D, H = 1, 2048, 640, 32
        Dh = D // H
        return {
            "x": _w((lambda *s: torch.randn(*s, dtype=torch.bfloat16) * 0.4)(B, S, D)),
            "wqkv": _w((lambda *s: torch.randn(*s, dtype=torch.bfloat16) * 0.4)(D, 3 * D)),
            "w_phi": _w((lambda *s: torch.randn(*s, dtype=torch.bfloat16) * 0.4)(H, Dh, Dh) * (Dh ** -0.5)),
            "wo": _w((lambda *s: torch.randn(*s, dtype=torch.bfloat16) * 0.05)(D, D)),
        }
    _A_in = _A_setup()

    def _B_setup():
        Bsz, L, D, N = 1, 2048, 640, 192
        return {
            "u": _w((lambda *s: torch.randn(*s, dtype=torch.bfloat16) * 0.05)(Bsz, L, D)),
            "log_A_real": _w((lambda *s: torch.randn(*s, dtype=torch.bfloat16) * 3.2)(D, N) * 0.5),
            "A_imag": _w((lambda *s: torch.randn(*s, dtype=torch.bfloat16) * 0.2)(D, N) * 3.14),
            "C_real": _w((lambda *s: torch.randn(*s, dtype=torch.bfloat16) * 3.2)(D, N) / N ** 0.5),
            "C_imag": _w((lambda *s: torch.randn(*s, dtype=torch.bfloat16) * 3.2)(D, N) / N ** 0.5),
            "log_dt": _w((lambda *s: torch.randn(*s, dtype=torch.bfloat16) * 0.2)(D) * 0.5 - 4.0),
            "D_skip": _w((lambda *s: torch.randn(*s, dtype=torch.bfloat16) * 0.4)(D)),
        }
    _B_in = _B_setup()

    return {
        "A_x": _A_in["x"],
        "A_wqkv": _A_in["wqkv"],
        "A_w_phi": _A_in["w_phi"],
        "A_wo": _A_in["wo"],
        "B_u": _B_in["u"],
        "B_log_A_real": _B_in["log_A_real"],
        "B_A_imag": _B_in["A_imag"],
        "B_C_real": _B_in["C_real"],
        "B_C_imag": _B_in["C_imag"],
        "B_log_dt": _B_in["log_dt"],
        "B_D_skip": _B_in["D_skip"],
    }

def reference(A_x, A_wqkv, A_w_phi, A_wo, B_u, B_log_A_real, B_A_imag, B_C_real, B_C_imag, B_log_dt, B_D_skip):
    def _A_ref(x, wqkv, w_phi, wo):
        B, S, D = x.shape
        H = 32; Dh = D // H
        qkv = (lambda x, *d: x.permute(*d))((x @ wqkv).reshape(B, S, 3, H, Dh), 2, 0, 3, 1, 4)
        q, k, v = qkv[0], qkv[1], qkv[2]
        pq = torch.einsum("bhsd,hdf->bhsf", q, w_phi)
        pk = torch.einsum("bhsd,hdf->bhsf", k, w_phi)
        phi_q = torch.concatenate([_softmax(pq, axis=-1), _softmax(-pq, axis=-1)], axis=-1)
        phi_k = torch.concatenate([_softmax(pk, axis=-1), _softmax(-pk, axis=-1)], axis=-1)
        kv = torch.einsum("bhsf,bhsd->bhfd", phi_k, v)
        z  = torch.einsum("bhsf->bhf", phi_k)
        num = torch.einsum("bhqf,bhfd->bhqd", phi_q, kv)
        den = torch.einsum("bhqf,bhf->bhq", phi_q, z)[..., None] + 1e-6
        o = num / den
        return (lambda x, *d: x.permute(*d))(o, 0, 2, 1, 3).reshape(B, S, D) @ wo

    def _B_ref(u, log_A_real, A_imag, C_real, C_imag, log_dt, D_skip):
        L = u.shape[1]
        dt = torch.exp(log_dt)
        A = -torch.exp(log_A_real) + 1j * A_imag
        C = (C_real + 1j * C_imag) * dt[:, None]
        pos = (lambda x, dt: x.to(dt))(torch.arange(L), log_dt.dtype)
        P = torch.exp((A * dt[:, None])[:, :, None] * pos[None, None, :])
        K = 2.0 * torch.einsum("dn,dnl->dl", C, P).real
        L2 = 2 * L
        u_t = (lambda x, *d: x.permute(*d))(u, 0, 2, 1)
        Kf = (lambda x, *a, **k: torch.fft.rfft(x.float(), *a, **k))(K, L2)
        Uf = (lambda x, *a, **k: torch.fft.rfft(x.float(), *a, **k))(u_t, L2)
        y = (lambda x, *a, **k: torch.fft.irfft(x, *a, **k).to(torch.bfloat16))(Uf * Kf[None, :, :], L2)[:, :, :L]
        y = (lambda x, *d: x.permute(*d))(y, 0, 2, 1)
        return y + u * D_skip[None, None, :]

    a = _A_ref(A_x, A_wqkv, A_w_phi, A_wo)
    b = _B_ref(B_u, B_log_A_real, B_A_imag, B_C_real, B_C_imag, B_log_dt, B_D_skip)
    return torch.concatenate([a, b], axis=-1)
```

```asm
; @launch grid=(256,1,1) block=(512,1,1) lds=163840
.amdgcn_target "amdgcn-amd-amdhsa--gfx950"
.text
.globl concat_heads__linear_kernel_hedgehog__ssm_conv_s4d__prompt_kernel
.p2align 8
.type concat_heads__linear_kernel_hedgehog__ssm_conv_s4d__prompt_kernel,@function
concat_heads__linear_kernel_hedgehog__ssm_conv_s4d__prompt_kernel:
    s_load_dwordx8 s[8:15], s[0:1], 0
    s_load_dwordx16 s[16:31], s[0:1], 32
    s_load_dwordx4 s[32:35], s[0:1], 96
    s_cmp_ge_u32 s2, 256
    s_cbranch_scc1 L_end
    v_lshrrev_b32 v2, 6, v0
    v_and_b32_e64 v1, 63, v0
    s_and_b32 s4, s2, 7
    v_readfirstlane_b32 s3, v2
    s_lshr_b32 s5, s2, 3
    s_add_u32 s101, s4, 1
    s_bfe_u32 s101, s101, 0x10001
    s_cselect_b32 s100, 20, 24
    s_cselect_b32 s98, 0, 20
    s_getpc_b64 s[6:7]
L_pc:
    s_lshl_b32 s36, s5, 10
    v_lshl_add_u32 v2, v2, 7, s36
    v_lshl_add_u32 v2, v1, 15, v2
    v_min_u32 v2, L_end-L_pc, v2
    s_mov_b64 exec, 3
    global_load_dword v31, v2, s[6:7]
    s_mov_b64 exec, -1
    s_cmp_ge_u32 s5, s100
    s_cbranch_scc1 L_B
L_A:
    s_cmp_gt_u32 s3, 1
    s_cbranch_scc1 L_a_nt
    s_mul_i32 s39, s98, 48
    s_mul_i32 s40, s5, 48
    s_add_u32 s39, s39, s40
    s_lshr_b32 s40, s4, 1
    s_mul_i32 s40, s40, 320
    s_and_b32 s40, s40, 0xff80
    s_mul_i32 s41, s5, 10
    s_lshl_b32 s42, s3, 1
    s_cselect_b32 s39, s41, s39
    s_cselect_b32 s40, s40, 0
    v_lshrrev_b32 v2, s42, v1
    v_add_u32 v2, s39, v2
    v_min_u32 v2, 2047, v2
    v_mul_u32_u24 v2, 1280, v2
    v_bfe_u32 v3, v1, 0, s42
    v_lshl_add_u32 v3, v3, 7, s40
    v_add_u32_e64 v2, v2, v3
    s_cselect_b32 exec_lo, 0x77777777, -1
    s_mov_b32 exec_hi, 65535
    s_cselect_b32 exec_hi, 119, exec_hi
    s_waitcnt lgkmcnt(0)
    s_cselect_b64 s[6:7], s[10:11], s[8:9]
    global_load_dword v31, v2, s[6:7]
    s_mov_b64 exec, -1
L_a_nt:
    s_add_u32 s39, s98, s5
    s_lshr_b32 s36, s39, 2
    s_add_u32 s39, s39, s36
    s_and_b32 s39, s39, 3
    s_lshr_b32 s40, s4, 1
    s_lshl_b32 s40, s40, 2
    s_add_u32 s37, s39, s40
    s_xor_b32 s38, s37, 1
    s_cmp_lt_u32 s3, 4
    s_cbranch_scc1 L_a_C
    s_setprio 1
    s_sub_u32 s60, s3, 4
    s_mov_b32 s46, 2621440
    s_mov_b32 s47, 0x20000
    s_mov_b32 s50, 2457600
    s_mov_b32 s51, 0x20000
    s_waitcnt lgkmcnt(0)
    s_mov_b64 s[44:45], s[8:9]
    s_mov_b64 s[48:49], s[10:11]
    v_lshrrev_b32_e64 v14, 3, v1
    v_lshrrev_b32 v15, 4, v1
    v_and_b32 v16, 7, v1
    s_and_b32 s40, s60, 1
    s_lshl_b32 s40, s40, 2
    v_xor_b32 v17, v15, v16
    v_xor_b32 v17, s40, v17
    v_mul_u32_u24 v19, 1280, v14
    v_lshl_add_u32 v2, v17, 4, v19
    v_and_b32_e64 v15, 1, v15
    v_lshlrev_b32 v15, 2, v15
    v_xor_b32 v17, v15, v16
    v_lshl_add_u32 v96, v17, 4, v19
    s_lshr_b32 s40, s40, 1
    v_lshrrev_b32 v15, 5, v1
    v_and_b32_e64 v17, 3, v1
    v_lshl_add_u32 v17, v15, 2, v17
    v_xor_b32_e64 v17, s40, v17
    v_bfe_u32 v14, v1, 2, 3
    v_mul_u32_u24 v18, 3840, v14
    v_lshl_add_u32 v18, v17, 4, v18
    s_mul_i32 s40, s37, 80
    s_and_b32 s40, s40, 0xffc0
    s_add_u32 s40, s40, 1280
    s_mul_i32 s41, s38, 80
    s_and_b32 s41, s41, 0xffc0
    v_add_u32 v8, s40, v18
    v_add_u32 v12, s41, v18
    v_add_u32 v10, 1280, v8
    s_and_b32 s40, s37, 3
    v_subrev_u32 v15, s40, v17
    v_cmp_gt_u32 s[70:71], 5, v15
    s_and_b32 s40, s38, 3
    v_subrev_u32 v15, s40, v17
    v_and_b32_e64 v15, 7, v15
    v_cmp_gt_u32 s[72:73], 6, v15
    v_cmp_eq_u32_e64 vcc, 5, v15
    v_mov_b32 v16, 2130706432
    s_nop 0
    v_cndmask_b32 v12, v12, v16, vcc
    v_add_u32 v3, 40960, v2
    v_add_u32 v4, 81920, v2
    v_add_u32 v5, 122880, v2
    v_add_u32 v6, 163840, v2
    v_add_u32 v7, 204800, v2
    v_add_u32 v9, 122880, v8
    v_add_u32 v11, 122880, v10
    v_add_u32 v13, 122880, v12
    s_mul_i32 s61, s36, 24
    s_add_u32 s61, s61, s60
    s_mul_i32 s61, s61, 10240
    s_mul_i32 s62, s60, 30720
    s_lshl_b32 m0, s60, 10
    s_mov_b32 s63, 0
L_l_loop:
    buffer_load_dwordx4 v2, s[44:47], s61 offen lds
    s_add_u32 m0, m0, 4096
    s_nop 0
    buffer_load_dwordx4 v3, s[44:47], s61 offen lds
    s_add_u32 m0, m0, 4096
    s_nop 0
    buffer_load_dwordx4 v4, s[44:47], s61 offen lds
    s_add_u32 m0, m0, 4096
    s_nop 0
    buffer_load_dwordx4 v5, s[44:47], s61 offen lds
    s_add_u32 m0, m0, 4096
    s_cmp_eq_u32 s63, 0
    s_cbranch_scc1 L_l_setup
L_l_back:
    buffer_load_dwordx4 v6, s[44:47], s61 offen lds
    s_add_u32 m0, m0, 4096
    s_nop 0
    buffer_load_dwordx4 v7, s[44:47], s61 offen lds
    s_add_u32 m0, m0, 4096
    s_mov_b64 exec, s[70:71]
    buffer_load_dwordx4 v8, s[48:51], s62 offen lds
    s_add_u32 m0, m0, 4096
    s_nop 0
    buffer_load_dwordx4 v9, s[48:51], s62 offen lds
    s_add_u32 m0, m0, 4096
    s_cmp_eq_u32 s63, 0
    s_cbranch_scc1 L_l_first
    s_waitcnt vmcnt(8)
    s_barrier
L_l_first:
    buffer_load_dwordx4 v10, s[48:51], s62 offen lds
    s_add_u32 m0, m0, 4096
    s_nop 0
    buffer_load_dwordx4 v11, s[48:51], s62 offen lds
    s_add_u32 m0, m0, 4096
    s_mov_b64 exec, s[72:73]
    buffer_load_dwordx4 v12, s[48:51], s62 offen lds
    s_add_u32 m0, m0, 4096
    s_nop 0
    buffer_load_dwordx4 v13, s[48:51], s62 offen lds
    s_add_u32 m0, m0, 4096
    s_mov_b64 exec, -1
    s_cmp_lt_u32 m0, 98304
    s_cselect_b32 s40, 147456, 0
    s_add_u32 m0, m0, s40
    s_sub_u32 m0, m0, 98304
    s_add_u32 s61, s61, 128
    s_add_u32 s62, s62, 245760
    s_add_u32 s63, s63, 1
    s_cmp_lt_u32 s63, 10
    s_cbranch_scc1 L_l_loop
    global_load_dword v109, v108, s[32:33] sc1
    s_add_u32 m0, s67, 20480
    s_add_u32 s39, s68, 204800
    buffer_load_dwordx4 v96, s[20:23], s39 offen lds
    s_add_u32 m0, s67, 24576
    s_add_u32 s39, s68, 245760
    buffer_load_dwordx4 v96, s[20:23], s39 offen lds
    s_add_u32 m0, s67, 28672
    s_add_u32 s39, s68, 286720
    buffer_load_dwordx4 v96, s[20:23], s39 offen lds
    s_add_u32 m0, s67, 32768
    s_add_u32 s39, s68, 327680
    buffer_load_dwordx4 v96, s[20:23], s39 offen lds
    s_add_u32 m0, s67, 36864
    s_add_u32 s39, s68, 368640
    buffer_load_dwordx4 v96, s[20:23], s39 offen lds
    s_add_u32 m0, s67, 40960
    s_add_u32 s39, s68, 409600
    buffer_load_dwordx4 v96, s[20:23], s39 offen lds
    s_waitcnt vmcnt(7)
    s_barrier
    s_add_u32 m0, s67, 45056
    s_add_u32 s39, s68, 450560
    buffer_load_dwordx4 v96, s[20:23], s39 offen lds
    s_add_u32 m0, s67, 49152
    s_add_u32 s39, s68, 491520
    buffer_load_dwordx4 v96, s[20:23], s39 offen lds
    s_add_u32 m0, s67, 53248
    s_add_u32 s39, s68, 532480
    buffer_load_dwordx4 v96, s[20:23], s39 offen lds
    s_add_u32 m0, s67, 57344
    s_add_u32 s39, s68, 573440
    buffer_load_dwordx4 v96, s[20:23], s39 offen lds
    s_add_u32 m0, s67, 61440
    s_add_u32 s39, s68, 614400
    buffer_load_dwordx4 v96, s[20:23], s39 offen lds
    s_add_u32 m0, s67, 65536
    s_add_u32 s39, s68, 655360
    buffer_load_dwordx4 v96, s[20:23], s39 offen lds
    s_add_u32 m0, s67, 69632
    s_add_u32 s39, s68, 696320
    buffer_load_dwordx4 v96, s[20:23], s39 offen lds
    s_add_u32 m0, s67, 73728
    s_add_u32 s39, s68, 737280
    buffer_load_dwordx4 v96, s[20:23], s39 offen lds
    s_add_u32 m0, s67, 77824
    s_add_u32 s39, s68, 778240
    buffer_load_dwordx4 v96, s[20:23], s39 offen lds
    s_waitcnt vmcnt(15)
    v_readfirstlane_b32 s41, v109
    s_mov_b32 s40, 0
    s_and_b32 s39, s41, 0xffff
    s_cmp_lt_u32 s39, 48
    s_cbranch_scc1 L_l_clr
L_l_clr_ok:
    s_cmp_gt_i32 s41, 0xffff
    s_cselect_b32 s41, 8192, 0
    v_mov_b32 v16, 49152
    v_mov_b32_e64 v15, s41
    s_add_u32 s52, s52, s41
    s_addc_u32 s53, s53, 0
    s_add_u32 s56, s56, s41
    s_addc_u32 s57, s57, 0
    s_barrier
    s_add_u32 m0, s67, 0
    s_add_u32 s39, s68, 0
    buffer_load_dwordx4 v96, s[20:23], s39 offen lds
    s_add_u32 m0, s67, 4096
    s_add_u32 s39, s68, 40960
    buffer_load_dwordx4 v96, s[20:23], s39 offen lds
    s_add_u32 m0, s67, 8192
    s_add_u32 s39, s68, 81920
    buffer_load_dwordx4 v96, s[20:23], s39 offen lds
    s_add_u32 m0, s67, 12288
    s_add_u32 s39, s68, 122880
    buffer_load_dwordx4 v96, s[20:23], s39 offen lds
    s_add_u32 m0, s67, 16384
    s_add_u32 s39, s68, 163840
    buffer_load_dwordx4 v96, s[20:23], s39 offen lds
    buffer_store_dwordx4 v[104:107], v103, s[52:55], s69 offen sc1
    buffer_store_dwordx4 v[104:107], v103, s[52:55], s69 offen offset:1024 sc1
    s_mov_b32 exec_hi, 0
    buffer_store_dwordx4 v[104:107], v103, s[52:55], s69 offen offset:2048 sc1
    s_mov_b32 exec_hi, -1
    buffer_store_dwordx4 v[104:107], v103, s[52:55], s43 offen sc1
    buffer_store_dwordx4 v[104:107], v103, s[52:55], s43 offen offset:1024 sc1
    s_mov_b32 exec_hi, 0
    buffer_store_dwordx4 v[104:107], v103, s[52:55], s43 offen offset:2048 sc1
    s_mov_b32 exec_hi, -1
    s_mov_b32 s63, 0
    s_waitcnt vmcnt(0)
    ds_write_b32 v16, v15
    s_waitcnt lgkmcnt(0)
    s_setprio 3
    s_barrier
    s_mov_b64 exec, 1
    buffer_store_dword v108, v108, s[56:59], s18 offen offset:3840 sc1
L_l_poll:
    s_mov_b64 exec, s[6:7]
    buffer_load_dword v110, v97, s[56:59], 0 offen offset:3840 sc1
    s_mov_b64 exec, -1
    s_cmp_lg_u32 s63, 0
    s_cbranch_scc1 L_l_nob
    s_barrier
L_l_nob:
    s_waitcnt vmcnt(0)
    s_sleep 1
    s_add_u32 s63, s63, 1
    s_cmp_ge_u32 s63, 4194304
    s_cbranch_scc1 L_l_got1
    v_cmp_eq_u32 s[6:7], -1, v110
    s_nop 0
    s_cmp_lg_u32 s6, 0
    s_cbranch_scc1 L_l_poll
    buffer_load_dwordx4 v[32:35], v98, s[56:59], 0 offen sc1
    buffer_load_dwordx4 v[36:39], v99, s[56:59], 0 offen sc1
    buffer_load_dwordx4 v[40:43], v100, s[56:59], 0 offen sc1
    buffer_load_dwordx4 v[44:47], v101, s[56:59], 0 offen sc1
    buffer_load_dwordx4 v[48:51], v98, s[56:59], s16 offen sc1
    buffer_load_dwordx4 v[52:55], v99, s[56:59], s16 offen sc1
    buffer_load_dwordx4 v[56:59], v100, s[56:59], s16 offen sc1
    buffer_load_dwordx4 v[60:63], v101, s[56:59], s16 offen sc1
    buffer_load_dwordx4 v[64:67], v98, s[56:59], s17 offen sc1
    buffer_load_dwordx4 v[68:71], v99, s[56:59], s17 offen sc1
    buffer_load_dwordx4 v[72:75], v100, s[56:59], s17 offen sc1
    buffer_load_dwordx4 v[76:79], v101, s[56:59], s17 offen sc1
    s_waitcnt vmcnt(11)
    v_mfma_f32_16x16x32_bf16 v[80:83], v[88:91], v[32:35], 0
    v_max3_u32 v11, v32, v33, 0
    v_max3_u32 v11, v11, v34, v35
    s_waitcnt vmcnt(10)
    v_mfma_f32_16x16x32_bf16 v[80:83], v[92:95], v[36:39], v[80:83]
    v_max3_u32 v11, v36, v37, v11
    v_max3_u32 v11, v11, v38, v39
    s_waitcnt vmcnt(9)
    v_mfma_f32_16x16x32_bf16 v[84:87], v[88:91], v[40:43], 0
    v_max3_u32 v11, v40, v41, v11
    v_max3_u32 v11, v11, v42, v43
    s_waitcnt vmcnt(8)
    v_mfma_f32_16x16x32_bf16 v[84:87], v[92:95], v[44:47], v[84:87]
    v_max3_u32 v11, v44, v45, v11
    v_max3_u32 v11, v11, v46, v47
    v_cmp_eq_u32 s[74:75], -1, v11
    s_waitcnt vmcnt(7)
    v_mfma_f32_16x16x32_bf16 v[80:83], v[88:91], v[48:51], v[80:83]
    v_max3_u32 v11, v48, v49, 0
    v_max3_u32 v11, v11, v50, v51
    s_waitcnt vmcnt(6)
    v_mfma_f32_16x16x32_bf16 v[80:83], v[92:95], v[52:55], v[80:83]
    v_max3_u32 v11, v52, v53, v11
    v_max3_u32 v11, v11, v54, v55
    s_waitcnt vmcnt(5)
    v_mfma_f32_16x16x32_bf16 v[84:87], v[88:91], v[56:59], v[84:87]
    v_max3_u32 v11, v56, v57, v11
    v_max3_u32 v11, v11, v58, v59
    s_waitcnt vmcnt(4)
    v_mfma_f32_16x16x32_bf16 v[84:87], v[92:95], v[60:63], v[84:87]
    v_max3_u32 v11, v60, v61, v11
    v_max3_u32 v11, v11, v62, v63
    v_cmp_eq_u32 s[76:77], -1, v11
    s_waitcnt vmcnt(3)
    v_mfma_f32_16x16x32_bf16 v[80:83], v[88:91], v[64:67], v[80:83]
    v_max3_u32 v11, v64, v65, 0
    v_max3_u32 v11, v11, v66, v67
    s_waitcnt vmcnt(2)
    v_mfma_f32_16x16x32_bf16 v[80:83], v[92:95], v[68:71], v[80:83]
    v_max3_u32 v11, v68, v69, v11
    v_max3_u32 v11, v11, v70, v71
    s_waitcnt vmcnt(1)
    v_mfma_f32_16x16x32_bf16 v[84:87], v[88:91], v[72:75], v[84:87]
    v_max3_u32 v11, v72, v73, v11
    v_max3_u32 v11, v11, v74, v75
    s_waitcnt vmcnt(0)
    v_mfma_f32_16x16x32_bf16 v[84:87], v[92:95], v[76:79], v[84:87]
    v_max3_u32 v11, v76, v77, v11
    v_max3_u32 v11, v11, v78, v79
    v_cmp_eq_u32 s[78:79], -1, v11
    s_or_b64 vcc, s[74:75], s[76:77]
    s_or_b64 vcc, vcc, s[78:79]
    s_cbranch_scc1 L_l_again
    s_nop 0
L_l_got1:
    v_cvt_pk_bf16_f32 v12, v80, v81
    v_cvt_pk_bf16_f32 v13, v82, v83
    v_cvt_pk_bf16_f32 v14, v84, v85
    v_cvt_pk_bf16_f32 v15, v86, v87
    ds_write_b64 v102, v[12:13]
    ds_write_b64 v102, v[14:15] offset:512
    s_waitcnt lgkmcnt(0)
    s_barrier
    s_mov_b64 exec, 1
    buffer_store_dword v108, v108, s[56:59], s28 offen offset:3968 sc1
    s_mov_b64 exec, -1
    s_endpgm
L_l_setup:
    s_cmp_ge_u32 s5, 10
    s_cselect_b32 s39, 10, 0
    s_cselect_b32 s40, 4, 0
    s_sub_u32 s39, s5, s39
    s_lshl_b32 s39, s39, 7
    s_mul_i32 s68, s60, 10240
    s_add_u32 s68, s68, s39
    s_lshl_b32 s67, s60, 10
    s_add_u32 s67, s67, 77824
    s_mov_b32 s20, s14
    s_mov_b32 s21, s15
    s_mov_b32 s22, 819200
    s_mov_b32 s23, 0x20000
    s_cmp_ge_u32 s5, 20
    s_cselect_b32 s22, 0, s22
    s_mov_b32 s52, s34
    s_mov_b32 s53, s35
    s_mov_b32 s54, 4194304
    s_mov_b32 s55, 0x20000
    s_add_u32 s56, s34, 4210688
    s_addc_u32 s57, s35, 0
    s_mov_b32 s58, 720896
    s_mov_b32 s59, 0x20000
    s_and_b32 s29, s37, 6
    s_lshr_b32 s39, s37, 3
    s_add_u32 s29, s29, s39
    s_and_b32 s39, s37, 1
    s_lshl1_add_u32 s29, s29, s39
    s_mul_i32 s40, s36, 6
    s_add_u32 s40, s40, s60
    s_lshr_b32 s39, s40, 1
    s_xor_b32 s39, s39, s40
    s_bfe_u32 s39, s39, 0x10004
    s_and_b32 s69, s40, 31
    s_lshl4_add_u32 s69, s69, s39
    s_lshl_b32 s69, s69, 13
    s_bitcmp1_b32 s40, 0
    s_cselect_b32 s39, 3072, 0
    s_add_u32 s69, s69, s39
    s_cmp_ge_u32 s40, 64
    s_cselect_b32 s69, 2130706432, s69
    s_add_u32 s40, s40, 4
    s_cmp_ge_u32 s60, 2
    s_cselect_b32 s40, 64, s40
    s_lshr_b32 s39, s40, 1
    s_xor_b32 s39, s39, s40
    s_bfe_u32 s39, s39, 0x10004
    s_and_b32 s43, s40, 31
    s_lshl4_add_u32 s43, s43, s39
    s_lshl_b32 s43, s43, 13
    s_bitcmp1_b32 s40, 0
    s_cselect_b32 s39, 3072, 0
    s_add_u32 s43, s43, s39
    s_cmp_ge_u32 s40, 64
    s_cselect_b32 s43, 2130706432, s43
    s_lshr_b32 s39, s38, 1
    s_lshl_b32 s39, s39, 14
    s_and_b32 s40, s38, 1
    s_mul_i32 s40, s40, 2560
    s_add_u32 s39, s39, s40
    s_add_u32 s69, s69, s39
    s_add_u32 s43, s43, s39
    v_lshlrev_b32 v103, 4, v1
    v_mov_b32 v104, -1
    v_mov_b32 v105, -1
    v_mov_b32 v106, -1
    v_mov_b32 v107, -1
    v_mov_b32 v108, 0
    v_mov_b32 v110, 0
    v_and_b32 v14, 15, v1
    v_lshrrev_b32 v15, 4, v1
    s_lshl_b32 s39, s60, 6
    v_add_u32 v16, s39, v14
    s_xor_b32 s40, s29, 1
    s_lshl_b32 s40, s40, 12
    v_lshl_add_u32 v17, v15, 16, s40
    v_add_u32_e64 v18, 0, v16
    v_min_u32 v18, 239, v18
    v_lshl_add_u32 v98, v18, 4, v17
    v_add_u32_e64 v18, 16, v16
    v_min_u32 v18, 239, v18
    v_lshl_add_u32 v99, v18, 4, v17
    v_add_u32_e64 v18, 32, v16
    v_min_u32 v18, 239, v18
    v_lshl_add_u32 v100, v18, 4, v17
    v_add_u32_e64 v18, 48, v16
    v_min_u32 v18, 239, v18
    v_lshl_add_u32 v101, v18, 4, v17
    v_lshrrev_b32_e64 v17, 1, v15
    v_lshl_add_u32 v16, v17, 4, v16
    v_and_b32 v17, 1, v15
    v_lshlrev_b32 v17, 3, v17
    v_lshl_add_u32 v102, v16, 4, v17
    v_add_u32 v102, 159744, v102
    v_and_b32 v16, 1, v14
    v_lshlrev_b32 v16, 4, v16
    v_mov_b32 v17, 0x3f80
    v_lshlrev_b32_e64 v16, v16, v17
    v_lshrrev_b32 v17, 1, v14
    v_cmp_eq_u32 vcc, 0, v17
    v_cmp_eq_u32 s[74:75], 1, v17
    s_nop 0
    v_cndmask_b32 v88, 0, v16, vcc
    v_cndmask_b32 v89, 0, v16, s[74:75]
    v_cmp_eq_u32_e64 vcc, 2, v17
    v_cmp_eq_u32 s[74:75], 3, v17
    s_nop 0
    v_cndmask_b32 v90, 0, v16, vcc
    v_cndmask_b32 v91, 0, v16, s[74:75]
    v_cmp_eq_u32_e64 vcc, 4, v17
    v_cmp_eq_u32 s[74:75], 5, v17
    s_nop 0
    v_cndmask_b32 v92, 0, v16, vcc
    v_cndmask_b32 v93, 0, v16, s[74:75]
    v_cmp_eq_u32_e64 vcc, 6, v17
    v_cmp_eq_u32 s[74:75], 7, v17
    s_nop 0
    v_cndmask_b32 v94, 0, v16, vcc
    v_cndmask_b32 v95, 0, v16, s[74:75]
    v_lshl_add_u32 v97, v14, 16, s40
    s_lshl_b32 s18, s36, 4
    s_add_u32 s18, s18, s29
    s_lshl_b32 s18, s18, 12
    s_andn2_b32 s28, s18, 0x2000
    s_bfe_u32 s39, s18, 0x1000d
    s_lshl_b32 s39, s39, 6
    s_add_u32 s28, s28, s39
    s_cmp_ge_u32 s36, 5
    s_cselect_b32 s39, 0x2000, 0
    s_add_u32 s28, s28, s39
    s_cmp_eq_u32 s60, 0
    s_cselect_b32 s18, s18, 2130706432
    s_cselect_b32 s28, s28, 2130706432
    s_mov_b32 s16, 262144
    s_mov_b32 s17, 524288
    s_mov_b64 s[6:7], 0xfff
    s_branch L_l_back
L_a_C:
    s_and_b32 s60, s3, 1
    s_lshr_b32 s61, s3, 1
    v_and_b32 v216, 31, v1
    v_lshrrev_b32_e64 v217, 5, v1
    v_bfe_u32 v218, v1, 2, 2
    v_and_b32_e64 v219, 3, v1
    v_bfe_u32 v220, v1, 4, 1
    v_lshrrev_b32 v221, 4, v1
    v_and_b32 v222, 15, v1
    s_mov_b32 s66, 0
    s_mov_b32 s67, -1
    v_bfe_u32 v224, v1, 1, 3
    v_xor_b32 v224, v224, v221
    v_lshlrev_b32 v224, 4, v224
    v_lshl_add_u32 v224, v222, 7, v224
    s_mul_i32 s39, s61, 12288
    v_add_u32 v2, s39, v224
    v_xor_b32 v3, 64, v2
    s_and_b32 s39, s37, 3
    s_lshl_b32 s39, s39, 4
    s_and_b32 s40, s38, 3
    s_lshl_b32 s40, s40, 4
    s_add_u32 s41, s40, 88
    s_mul_i32 s42, s60, 40
    s_add_u32 s39, s39, s42
    s_add_u32 s40, s40, s42
    s_add_u32 s40, s40, 16384
    s_lshl_b32 s42, s60, 3
    s_sub_u32 s41, s41, s42
    s_and_b32 s41, s41, 127
    s_add_u32 s41, s41, 16384
    v_lshl_add_u32 v224, v221, 4, v218
    v_lshlrev_b32 v224, 6, v224
    v_add_u32 v224, 24576, v224
    v_lshlrev_b32_e64 v225, 5, v220
    v_and_b32 v226, 1, v219
    v_lshrrev_b32 v227, 1, v219
    v_lshl_add_u32 v227, v226, 1, v227
    v_lshl_add_u32 v4, v227, 3, s39
    v_lshl_add_u32 v6, v227, 3, s40
    s_add_u32 s39, s39, 32
    s_add_u32 s40, s40, 32
    v_lshl_add_u32 v5, v226, 13, s39
    v_mov_b32_e64 v226, s40
    v_mov_b32 v227, s41
    v_cmp_eq_u32 vcc, 2, v219
    s_nop 1
    v_cndmask_b32 v5, v5, v226, vcc
    v_cmp_eq_u32 vcc, 3, v219
    s_nop 1
    v_cndmask_b32 v5, v5, v227, vcc
    v_and_b32 v226, 64, v4
    v_mad_u32_u24 v226, v226, 7, v224
    v_xad_u32 v4, v4, v225, v226
    v_and_b32_e64 v226, 64, v5
    v_mad_u32_u24 v226, v226, 7, v224
    v_xad_u32 v5, v5, v225, v226
    v_and_b32_e64 v226, 64, v6
    v_mad_u32_u24 v226, v226, 7, v224
    v_xad_u32 v6, v6, v225, v226
    s_lshl_b32 s39, s37, 1
    s_add_u32 s39, s39, s60
    s_mul_i32 s39, s39, 800
    s_lshl_b32 s40, s38, 1
    s_add_u32 s40, s40, s60
    s_mul_i32 s40, s40, 800
    v_lshlrev_b32 v29, 4, v1
    s_lshl_b32 s41, s3, 11
    s_add_u32 s41, s41, 147456
    s_mov_b32 m0, s41
    s_waitcnt lgkmcnt(0)
    s_mov_b32 s44, s12
    s_mov_b32 s45, s13
    s_mov_b32 s46, 25600
    s_mov_b32 s47, 0x20000
    buffer_load_dwordx4 v29, s[44:47], s39 offen lds
    s_add_u32 m0, m0, 1024
    s_nop 0
    buffer_load_dwordx4 v29, s[44:47], s40 offen lds
    s_mov_b32 s52, s34
    s_mov_b32 s53, s35
    s_mov_b32 s54, 4194304
    s_mov_b32 s55, 0x20000
    s_add_u32 s56, s34, 4210688
    s_addc_u32 s57, s35, 0
    s_mov_b32 s58, 720896
    s_mov_b32 s59, 0x20000
    s_and_b32 s29, s37, 6
    s_lshr_b32 s39, s37, 3
    s_add_u32 s29, s29, s39
    s_and_b32 s39, s37, 1
    s_lshl1_add_u32 s29, s29, s39
    s_setprio 2
    s_barrier
    s_nop 0
    ds_read_b64_tr_b16 v[232:233], v4 offset:0
    ds_read_b64_tr_b16 v[234:235], v4 offset:256
    ds_read_b128 v[128:131], v2 offset:0
    ds_read_b64_tr_b16 v[236:237], v4 offset:4096
    ds_read_b64_tr_b16 v[238:239], v4 offset:4352
    ds_read_b128 v[132:135], v3 offset:0
    ds_read_b64_tr_b16 v[240:241], v4 offset:8192
    ds_read_b64_tr_b16 v[242:243], v4 offset:8448
    ds_read_b64_tr_b16 v[244:245], v4 offset:12288
    ds_read_b64_tr_b16 v[246:247], v4 offset:12544
    ds_read_b64_tr_b16 v[168:169], v5 offset:0
    ds_read_b64_tr_b16 v[170:171], v5 offset:256
    ds_read_b64_tr_b16 v[172:173], v5 offset:4096
    ds_read_b64_tr_b16 v[174:175], v5 offset:4352
    ds_read_b64_tr_b16 v[176:177], v6 offset:0
    ds_read_b64_tr_b16 v[178:179], v6 offset:256
    ds_read_b64_tr_b16 v[180:181], v6 offset:4096
    ds_read_b64_tr_b16 v[182:183], v6 offset:4352
    ds_read_b128 v[136:139], v2 offset:2048
    ds_read_b128 v[140:143], v3 offset:2048
    s_waitcnt lgkmcnt(14)
    v_mfma_f32_16x16x32_bf16 v[32:35], v[232:235], v[128:131], 0
    ds_read_b128 v[144:147], v2 offset:4096
    v_mfma_f32_16x16x32_bf16 v[32:35], v[236:239], v[132:135], v[32:35]
    ds_read_b128 v[148:151], v3 offset:4096
    s_waitcnt lgkmcnt(14)
    v_mfma_f32_16x16x32_bf16 v[40:43], v[240:243], v[128:131], 0
    v_and_b32 v224, 9, v1
    s_waitcnt lgkmcnt(12)
    v_mfma_f32_16x16x32_bf16 v[40:43], v[244:247], v[132:135], v[40:43]
    v_bfe_u32 v225, v1, 2, 1
    v_lshl_or_b32 v224, v225, 1, v224
    s_waitcnt lgkmcnt(10)
    v_mfma_f32_16x16x32_bf16 v[48:51], v[168:171], v[128:131], 0
    v_bfe_u32 v225, v1, 1, 1
    s_waitcnt lgkmcnt(8)
    v_mfma_f32_16x16x32_bf16 v[48:51], v[172:175], v[132:135], v[48:51]
    v_lshl_or_b32 v224, v225, 2, v224
    s_lshl_b32 s39, s60, 1
    s_waitcnt lgkmcnt(6)
    v_mfma_f32_16x16x32_bf16 v[56:59], v[176:179], v[128:131], 0
    s_add_u32 s39, s39, s61
    s_waitcnt lgkmcnt(4)
    v_mfma_f32_16x16x32_bf16 v[56:59], v[180:183], v[132:135], v[56:59]
    s_mul_i32 s39, s39, 12288
    v_lshl_add_u32 v225, v216, 7, s39
    s_waitcnt lgkmcnt(2)
    v_mfma_f32_16x16x32_bf16 v[36:39], v[232:235], v[136:139], 0
    ds_read_b128 v[128:131], v2 offset:6144
    v_mfma_f32_16x16x32_bf16 v[36:39], v[236:239], v[140:143], v[36:39]
    ds_read_b128 v[132:135], v3 offset:6144
    v_mfma_f32_16x16x32_bf16 v[44:47], v[240:243], v[136:139], 0
    v_mul_u32_u24 v226, 5, v217
    v_mfma_f32_16x16x32_bf16 v[44:47], v[244:247], v[140:143], v[44:47]
    v_add_u32 v227, 0, v226
    v_xor_b32 v227, v227, v224
    v_mfma_f32_16x16x32_bf16 v[52:55], v[168:171], v[136:139], 0
    v_lshl_add_u32 v8, v227, 3, v225
    v_mfma_f32_16x16x32_bf16 v[52:55], v[172:175], v[140:143], v[52:55]
    v_add_u32 v227, 1, v226
    v_xor_b32 v227, v227, v224
    v_mfma_f32_16x16x32_bf16 v[60:63], v[176:179], v[136:139], 0
    v_lshl_add_u32 v9, v227, 3, v225
    v_mfma_f32_16x16x32_bf16 v[60:63], v[180:183], v[140:143], v[60:63]
    v_add_u32_e64 v227, 2, v226
    v_xor_b32 v227, v227, v224
    s_waitcnt lgkmcnt(2)
    v_mfma_f32_16x16x32_bf16 v[64:67], v[232:235], v[144:147], 0
    ds_read_b128 v[136:139], v2 offset:8192
    v_mfma_f32_16x16x32_bf16 v[64:67], v[236:239], v[148:151], v[64:67]
    ds_read_b128 v[140:143], v3 offset:8192
    v_mfma_f32_16x16x32_bf16 v[72:75], v[240:243], v[144:147], 0
    v_lshl_add_u32 v10, v227, 3, v225
    v_mfma_f32_16x16x32_bf16 v[72:75], v[244:247], v[148:151], v[72:75]
    v_add_u32 v227, 3, v226
    v_xor_b32 v227, v227, v224
    v_mfma_f32_16x16x32_bf16 v[80:83], v[168:171], v[144:147], 0
    v_lshl_add_u32 v11, v227, 3, v225
    v_mfma_f32_16x16x32_bf16 v[80:83], v[172:175], v[148:151], v[80:83]
    v_add_u32 v227, 4, v226
    v_xor_b32 v227, v227, v224
    v_mfma_f32_16x16x32_bf16 v[88:91], v[176:179], v[144:147], 0
    v_lshl_add_u32 v12, v227, 3, v225
    v_mfma_f32_16x16x32_bf16 v[88:91], v[180:183], v[148:151], v[88:91]
    v_add_u32_e64 v227, 10, v217
    v_xor_b32 v227, v227, v224
    s_waitcnt lgkmcnt(2)
    v_mfma_f32_16x16x32_bf16 v[68:71], v[232:235], v[128:131], 0
    ds_read_b128 v[144:147], v2 offset:10240
    v_mfma_f32_16x16x32_bf16 v[68:71], v[236:239], v[132:135], v[68:71]
    ds_read_b128 v[148:151], v3 offset:10240
    v_mfma_f32_16x16x32_bf16 v[76:79], v[240:243], v[128:131], 0
    v_add_u32 v2, 98304, v2
    v_mfma_f32_16x16x32_bf16 v[76:79], v[244:247], v[132:135], v[76:79]
    v_add_u32 v3, 98304, v3
    v_mfma_f32_16x16x32_bf16 v[84:87], v[168:171], v[128:131], 0
    v_add_u32 v4, 98304, v4
    v_mfma_f32_16x16x32_bf16 v[84:87], v[172:175], v[132:135], v[84:87]
    v_add_u32 v5, 98304, v5
    v_mfma_f32_16x16x32_bf16 v[92:95], v[176:179], v[128:131], 0
    v_add_u32 v6, 98304, v6
    v_mfma_f32_16x16x32_bf16 v[92:95], v[180:183], v[132:135], v[92:95]
    v_lshl_add_u32 v15, v227, 3, v225
    v_lshl_add_u32 v225, v222, 7, s39
    s_waitcnt lgkmcnt(0)
    s_barrier
    v_mfma_f32_16x16x32_bf16 v[96:99], v[232:235], v[136:139], 0
    ds_read_b64_tr_b16 v[152:153], v4 offset:0
    ds_read_b64_tr_b16 v[154:155], v4 offset:256
    v_mfma_f32_16x16x32_bf16 v[96:99], v[236:239], v[140:143], v[96:99]
    ds_read_b128 v[128:131], v2 offset:0
    ds_read_b64_tr_b16 v[156:157], v4 offset:4096
    v_mfma_f32_16x16x32_bf16 v[104:107], v[240:243], v[136:139], 0
    ds_read_b64_tr_b16 v[158:159], v4 offset:4352
    v_mfma_f32_16x16x32_bf16 v[104:107], v[244:247], v[140:143], v[104:107]
    ds_read_b128 v[132:135], v3 offset:0
    v_mfma_f32_16x16x32_bf16 v[112:115], v[168:171], v[136:139], 0
    ds_read_b64_tr_b16 v[160:161], v4 offset:8192
    v_mfma_f32_16x16x32_bf16 v[112:115], v[172:175], v[140:143], v[112:115]
    ds_read_b64_tr_b16 v[162:163], v4 offset:8448
    v_mfma_f32_16x16x32_bf16 v[120:123], v[176:179], v[136:139], 0
    ds_read_b64_tr_b16 v[164:165], v4 offset:12288
    v_mfma_f32_16x16x32_bf16 v[120:123], v[180:183], v[140:143], v[120:123]
    ds_read_b64_tr_b16 v[166:167], v4 offset:12544
    v_mfma_f32_16x16x32_bf16 v[100:103], v[232:235], v[144:147], 0
    ds_read_b128 v[136:139], v2 offset:2048
    ds_read_b128 v[140:143], v3 offset:2048
    v_mfma_f32_16x16x32_bf16 v[100:103], v[236:239], v[148:151], v[100:103]
    v_lshl_add_u32 v227, v220, 1, v217
    v_add_u32_e64 v227, 12, v227
    v_mfma_f32_16x16x32_bf16 v[108:111], v[240:243], v[144:147], 0
    v_xor_b32_e64 v227, v227, v224
    v_mfma_f32_16x16x32_bf16 v[108:111], v[244:247], v[148:151], v[108:111]
    v_lshl_add_u32 v13, v227, 3, v225
    v_and_b32_e64 v224, 1, v218
    v_mfma_f32_16x16x32_bf16 v[116:119], v[168:171], v[144:147], 0
    ds_read_b64_tr_b16 v[168:169], v5 offset:0
    ds_read_b64_tr_b16 v[170:171], v5 offset:256
    v_mfma_f32_16x16x32_bf16 v[116:119], v[172:175], v[148:151], v[116:119]
    ds_read_b64_tr_b16 v[172:173], v5 offset:4096
    ds_read_b64_tr_b16 v[174:175], v5 offset:4352
    v_mfma_f32_16x16x32_bf16 v[124:127], v[176:179], v[144:147], 0
    ds_read_b64_tr_b16 v[176:177], v6 offset:0
    ds_read_b64_tr_b16 v[178:179], v6 offset:256
    v_mfma_f32_16x16x32_bf16 v[124:127], v[180:183], v[148:151], v[124:127]
    ds_read_b64_tr_b16 v[180:181], v6 offset:4096
    ds_read_b64_tr_b16 v[182:183], v6 offset:4352
    s_waitcnt lgkmcnt(10)
    v_mfma_f32_16x16x32_bf16 v[32:35], v[152:155], v[128:131], v[32:35]
    ds_read_b128 v[144:147], v2 offset:4096
    v_mfma_f32_16x16x32_bf16 v[32:35], v[156:159], v[132:135], v[32:35]
    ds_read_b128 v[148:151], v3 offset:4096
    v_mfma_f32_16x16x32_bf16 v[40:43], v[160:163], v[128:131], v[40:43]
    v_lshrrev_b32 v225, 1, v218
    v_mfma_f32_16x16x32_bf16 v[40:43], v[164:167], v[132:135], v[40:43]
    v_lshl_or_b32 v224, v225, 2, v224
    v_lshl_or_b32 v224, v220, 3, v224
    s_waitcnt lgkmcnt(8)
    v_mfma_f32_16x16x32_bf16 v[48:51], v[168:171], v[128:131], v[48:51]
    v_xor_b32_e64 v224, v224, v219
    s_waitcnt lgkmcnt(6)
    v_mfma_f32_16x16x32_bf16 v[48:51], v[172:175], v[132:135], v[48:51]
    v_lshl_add_u32 v225, v221, 3, v218
    s_mul_i32 s39, s60, 24576
    s_waitcnt lgkmcnt(4)
    v_mfma_f32_16x16x32_bf16 v[56:59], v[176:179], v[128:131], v[56:59]
    v_lshl_add_u32 v225, v225, 7, s39
    s_waitcnt lgkmcnt(2)
    v_mfma_f32_16x16x32_bf16 v[56:59], v[180:183], v[132:135], v[56:59]
    v_lshl_add_u32 v16, v224, 3, v225
    v_xor_b32_e64 v18, 32, v16
    v_mfma_f32_16x16x32_bf16 v[36:39], v[152:155], v[136:139], v[36:39]
    ds_read_b128 v[128:131], v2 offset:6144
    v_mfma_f32_16x16x32_bf16 v[36:39], v[156:159], v[140:143], v[36:39]
    ds_read_b128 v[132:135], v3 offset:6144
    v_mfma_f32_16x16x32_bf16 v[44:47], v[160:163], v[136:139], v[44:47]
    v_xor_b32_e64 v20, 64, v16
    v_mfma_f32_16x16x32_bf16 v[44:47], v[164:167], v[140:143], v[44:47]
    s_lshl_b32 s39, s61, 5
    s_xor_b32 s39, s39, 0x60
    v_mfma_f32_16x16x32_bf16 v[52:55], v[168:171], v[136:139], v[52:55]
    v_xor_b32 v22, s39, v16
    v_mfma_f32_16x16x32_bf16 v[52:55], v[172:175], v[140:143], v[52:55]
    v_xor_b32 v17, 16, v16
    v_xor_b32 v19, 16, v18
    v_mfma_f32_16x16x32_bf16 v[60:63], v[176:179], v[136:139], v[60:63]
    v_xor_b32_e64 v21, 16, v20
    v_mfma_f32_16x16x32_bf16 v[60:63], v[180:183], v[140:143], v[60:63]
    v_xor_b32_e64 v23, 16, v22
    v_bfe_u32 v224, v1, 2, 1
    s_waitcnt lgkmcnt(2)
    v_mfma_f32_16x16x32_bf16 v[64:67], v[152:155], v[144:147], v[64:67]
    ds_read_b128 v[136:139], v2 offset:8192
    v_mfma_f32_16x16x32_bf16 v[64:67], v[156:159], v[148:151], v[64:67]
    ds_read_b128 v[140:143], v3 offset:8192
    v_mfma_f32_16x16x32_bf16 v[72:75], v[160:163], v[144:147], v[72:75]
    v_bfe_u32 v225, v1, 3, 1
    v_mfma_f32_16x16x32_bf16 v[72:75], v[164:167], v[148:151], v[72:75]
    v_lshl_add_u32 v225, v224, 1, v225
    v_lshl_add_u32 v225, v225, 2, v219
    v_mfma_f32_16x16x32_bf16 v[80:83], v[168:171], v[144:147], v[80:83]
    v_add_u32 v226, 80, v219
    v_mfma_f32_16x16x32_bf16 v[80:83], v[172:175], v[148:151], v[80:83]
    v_cmp_le_u32 vcc, 16, v216
    s_nop 1
    v_cndmask_b32 v225, v225, v226, vcc
    v_mfma_f32_16x16x32_bf16 v[88:91], v[176:179], v[144:147], v[88:91]
    v_cndmask_b32 v224, 8, 7, vcc
    v_mfma_f32_16x16x32_bf16 v[88:91], v[180:183], v[148:151], v[88:91]
    v_mov_b32 v226, 84
    v_cmp_le_u32 vcc, 24, v216
    s_waitcnt lgkmcnt(2)
    v_mfma_f32_16x16x32_bf16 v[68:71], v[152:155], v[128:131], v[68:71]
    ds_read_b128 v[144:147], v2 offset:10240
    v_mfma_f32_16x16x32_bf16 v[68:71], v[156:159], v[132:135], v[68:71]
    ds_read_b128 v[148:151], v3 offset:10240
    v_mfma_f32_16x16x32_bf16 v[76:79], v[160:163], v[128:131], v[76:79]
    v_add_u32 v2, -49152, v2
    v_mfma_f32_16x16x32_bf16 v[76:79], v[164:167], v[132:135], v[76:79]
    v_add_u32 v3, -49152, v3
    v_mfma_f32_16x16x32_bf16 v[84:87], v[168:171], v[128:131], v[84:87]
    v_add_u32 v4, -49152, v4
    v_mfma_f32_16x16x32_bf16 v[84:87], v[172:175], v[132:135], v[84:87]
    v_add_u32 v5, -49152, v5
    v_mfma_f32_16x16x32_bf16 v[92:95], v[176:179], v[128:131], v[92:95]
    v_add_u32 v6, -49152, v6
    v_mfma_f32_16x16x32_bf16 v[92:95], v[180:183], v[132:135], v[92:95]
    v_cndmask_b32_e64 v225, v225, v226, vcc
    s_mul_i32 s39, s60, 1920
    s_waitcnt lgkmcnt(0)
    s_barrier
    v_mfma_f32_16x16x32_bf16 v[96:99], v[152:155], v[136:139], v[96:99]
    ds_read_b64_tr_b16 v[232:233], v4 offset:0
    ds_read_b64_tr_b16 v[234:235], v4 offset:256
    v_mfma_f32_16x16x32_bf16 v[96:99], v[156:159], v[140:143], v[96:99]
    ds_read_b128 v[128:131], v2 offset:0
    ds_read_b64_tr_b16 v[236:237], v4 offset:4096
    v_mfma_f32_16x16x32_bf16 v[104:107], v[160:163], v[136:139], v[104:107]
    ds_read_b64_tr_b16 v[238:239], v4 offset:4352
    v_mfma_f32_16x16x32_bf16 v[104:107], v[164:167], v[140:143], v[104:107]
    ds_read_b128 v[132:135], v3 offset:0
    v_mfma_f32_16x16x32_bf16 v[112:115], v[168:171], v[136:139], v[112:115]
    ds_read_b64_tr_b16 v[240:241], v4 offset:8192
    v_mfma_f32_16x16x32_bf16 v[112:115], v[172:175], v[140:143], v[112:115]
    ds_read_b64_tr_b16 v[242:243], v4 offset:8448
    v_mfma_f32_16x16x32_bf16 v[120:123], v[176:179], v[136:139], v[120:123]
    ds_read_b64_tr_b16 v[244:245], v4 offset:12288
    v_mfma_f32_16x16x32_bf16 v[120:123], v[180:183], v[140:143], v[120:123]
    ds_read_b64_tr_b16 v[246:247], v4 offset:12544
    v_mfma_f32_16x16x32_bf16 v[100:103], v[152:155], v[144:147], v[100:103]
    ds_read_b128 v[136:139], v2 offset:2048
    ds_read_b128 v[140:143], v3 offset:2048
    v_mfma_f32_16x16x32_bf16 v[100:103], v[156:159], v[148:151], v[100:103]
    s_add_u32 s39, s39, 159744
    v_lshl_add_u32 v225, v225, 4, s39
    v_mfma_f32_16x16x32_bf16 v[108:111], v[160:163], v[144:147], v[108:111]
    v_cndmask_b32 v226, 0, 1, s[66:67]
    v_mfma_f32_16x16x32_bf16 v[108:111], v[164:167], v[148:151], v[108:111]
    v_cndmask_b32 v227, 0, 8, s[66:67]
    v_lshl_add_u32 v226, v226, v224, v227
    v_mfma_f32_16x16x32_bf16 v[116:119], v[168:171], v[144:147], v[116:119]
    ds_read_b64_tr_b16 v[168:169], v5 offset:0
    ds_read_b64_tr_b16 v[170:171], v5 offset:256
    v_mfma_f32_16x16x32_bf16 v[116:119], v[172:175], v[148:151], v[116:119]
    ds_read_b64_tr_b16 v[172:173], v5 offset:4096
    ds_read_b64_tr_b16 v[174:175], v5 offset:4352
    v_mfma_f32_16x16x32_bf16 v[124:127], v[176:179], v[144:147], v[124:127]
    ds_read_b64_tr_b16 v[176:177], v6 offset:0
    ds_read_b64_tr_b16 v[178:179], v6 offset:256
    v_mfma_f32_16x16x32_bf16 v[124:127], v[180:183], v[148:151], v[124:127]
    ds_read_b64_tr_b16 v[180:181], v6 offset:4096
    ds_read_b64_tr_b16 v[182:183], v6 offset:4352
    s_waitcnt lgkmcnt(10)
    v_mfma_f32_16x16x32_bf16 v[32:35], v[232:235], v[128:131], v[32:35]
    ds_read_b128 v[144:147], v2 offset:4096
    v_mfma_f32_16x16x32_bf16 v[32:35], v[236:239], v[132:135], v[32:35]
    ds_read_b128 v[148:151], v3 offset:4096
    v_mfma_f32_16x16x32_bf16 v[40:43], v[240:243], v[128:131], v[40:43]
    v_add_u32 v24, v225, v226
    v_mfma_f32_16x16x32_bf16 v[40:43], v[244:247], v[132:135], v[40:43]
    v_cndmask_b32 v226, 1, 2, s[66:67]
    v_cndmask_b32 v227, 0, 8, s[66:67]
    s_waitcnt lgkmcnt(8)
    v_mfma_f32_16x16x32_bf16 v[48:51], v[168:171], v[128:131], v[48:51]
    v_lshl_add_u32 v226, v226, v224, v227
    s_waitcnt lgkmcnt(6)
    v_mfma_f32_16x16x32_bf16 v[48:51], v[172:175], v[132:135], v[48:51]
    v_add_u32_e64 v25, v225, v226
    v_cndmask_b32 v226, 2, 3, s[66:67]
    s_waitcnt lgkmcnt(4)
    v_mfma_f32_16x16x32_bf16 v[56:59], v[176:179], v[128:131], v[56:59]
    v_cndmask_b32 v227, 0, 8, s[66:67]
    s_waitcnt lgkmcnt(2)
    v_mfma_f32_16x16x32_bf16 v[56:59], v[180:183], v[132:135], v[56:59]
    v_lshl_add_u32 v226, v226, v224, v227
    v_add_u32_e64 v26, v225, v226
    v_mfma_f32_16x16x32_bf16 v[36:39], v[232:235], v[136:139], v[36:39]
    ds_read_b128 v[128:131], v2 offset:6144
    v_mfma_f32_16x16x32_bf16 v[36:39], v[236:239], v[140:143], v[36:39]
    ds_read_b128 v[132:135], v3 offset:6144
    v_mfma_f32_16x16x32_bf16 v[44:47], v[240:243], v[136:139], v[44:47]
    v_cndmask_b32 v226, 3, 4, s[66:67]
    v_mfma_f32_16x16x32_bf16 v[44:47], v[244:247], v[140:143], v[44:47]
    v_cndmask_b32 v227, 0, 0, s[66:67]
    v_lshl_add_u32 v226, v226, v224, v227
    v_mfma_f32_16x16x32_bf16 v[52:55], v[168:171], v[136:139], v[52:55]
    v_add_u32_e64 v27, v225, v226
    v_mfma_f32_16x16x32_bf16 v[52:55], v[172:175], v[140:143], v[52:55]
    v_cndmask_b32 v226, 0, 4, s[66:67]
    v_cndmask_b32 v227, 8, 8, s[66:67]
    v_mfma_f32_16x16x32_bf16 v[60:63], v[176:179], v[136:139], v[60:63]
    v_lshl_add_u32 v226, v226, v224, v227
    v_mfma_f32_16x16x32_bf16 v[60:63], v[180:183], v[140:143], v[60:63]
    v_add_u32_e64 v28, v225, v226
    s_lshl_b32 s39, s36, 4
    s_waitcnt lgkmcnt(2)
    v_mfma_f32_16x16x32_bf16 v[64:67], v[232:235], v[144:147], v[64:67]
    ds_read_b128 v[136:139], v2 offset:8192
    v_mfma_f32_16x16x32_bf16 v[64:67], v[236:239], v[148:151], v[64:67]
    ds_read_b128 v[140:143], v3 offset:8192
    v_mfma_f32_16x16x32_bf16 v[72:75], v[240:243], v[144:147], v[72:75]
    s_add_u32 s39, s39, s29
    v_mfma_f32_16x16x32_bf16 v[72:75], v[244:247], v[148:151], v[72:75]
    s_lshl_b32 s39, s39, 12
    s_mul_i32 s40, s60, 1920
    v_mfma_f32_16x16x32_bf16 v[80:83], v[168:171], v[144:147], v[80:83]
    s_add_u32 s39, s39, s40
    v_mfma_f32_16x16x32_bf16 v[80:83], v[172:175], v[148:151], v[80:83]
    s_mul_i32 s40, s61, 1152
    s_add_u32 s39, s39, s40
    v_mfma_f32_16x16x32_bf16 v[88:91], v[176:179], v[144:147], v[88:91]
    v_lshl_add_u32 v225, v222, 4, s39
    v_mfma_f32_16x16x32_bf16 v[88:91], v[180:183], v[148:151], v[88:91]
    s_lshl_b32 s40, s61, 3
    v_mov_b32 v227, 2130706432
    s_waitcnt lgkmcnt(2)
    v_mfma_f32_16x16x32_bf16 v[68:71], v[232:235], v[128:131], v[68:71]
    ds_read_b128 v[144:147], v2 offset:10240
    v_mfma_f32_16x16x32_bf16 v[68:71], v[236:239], v[132:135], v[68:71]
    ds_read_b128 v[148:151], v3 offset:10240
    v_mfma_f32_16x16x32_bf16 v[76:79], v[240:243], v[128:131], v[76:79]
    v_add_u32 v2, -49152, v2
    v_mfma_f32_16x16x32_bf16 v[76:79], v[244:247], v[132:135], v[76:79]
    v_add_u32 v3, -49152, v3
    v_mfma_f32_16x16x32_bf16 v[84:87], v[168:171], v[128:131], v[84:87]
    v_add_u32 v4, -49152, v4
    v_mfma_f32_16x16x32_bf16 v[84:87], v[172:175], v[132:135], v[84:87]
    v_add_u32 v5, -49152, v5
    v_mfma_f32_16x16x32_bf16 v[92:95], v[176:179], v[128:131], v[92:95]
    v_add_u32 v6, -49152, v6
    v_mfma_f32_16x16x32_bf16 v[92:95], v[180:183], v[132:135], v[92:95]
    v_cmp_gt_u32_e64 vcc, s40, v222
    s_nop 1
    v_cndmask_b32 v225, v225, v227, vcc
    s_waitcnt lgkmcnt(0)
    s_barrier
    v_mfma_f32_16x16x32_bf16 v[96:99], v[232:235], v[136:139], v[96:99]
    ds_read_b64_tr_b16 v[152:153], v4 offset:0
    ds_read_b64_tr_b16 v[154:155], v4 offset:256
    v_mfma_f32_16x16x32_bf16 v[96:99], v[236:239], v[140:143], v[96:99]
    ds_read_b128 v[128:131], v2 offset:0
    ds_read_b64_tr_b16 v[156:157], v4 offset:4096
    v_mfma_f32_16x16x32_bf16 v[104:107], v[240:243], v[136:139], v[104:107]
    ds_read_b64_tr_b16 v[158:159], v4 offset:4352
    v_mfma_f32_16x16x32_bf16 v[104:107], v[244:247], v[140:143], v[104:107]
    ds_read_b128 v[132:135], v3 offset:0
    v_mfma_f32_16x16x32_bf16 v[112:115], v[168:171], v[136:139], v[112:115]
    ds_read_b64_tr_b16 v[160:161], v4 offset:8192
    v_mfma_f32_16x16x32_bf16 v[112:115], v[172:175], v[140:143], v[112:115]
    ds_read_b64_tr_b16 v[162:163], v4 offset:8448
    v_mfma_f32_16x16x32_bf16 v[120:123], v[176:179], v[136:139], v[120:123]
    ds_read_b64_tr_b16 v[164:165], v4 offset:12288
    v_mfma_f32_16x16x32_bf16 v[120:123], v[180:183], v[140:143], v[120:123]
    ds_read_b64_tr_b16 v[166:167], v4 offset:12544
    v_mfma_f32_16x16x32_bf16 v[100:103], v[232:235], v[144:147], v[100:103]
    ds_read_b128 v[136:139], v2 offset:2048
    ds_read_b128 v[140:143], v3 offset:2048
    v_mfma_f32_16x16x32_bf16 v[100:103], v[236:239], v[148:151], v[100:103]
    s_sub_u32 s40, 8, s61
    v_lshl_add_u32 v251, v221, s40, v225
    v_mfma_f32_16x16x32_bf16 v[108:111], v[240:243], v[144:147], v[108:111]
    s_lshl_b32 s40, 4, s40
    v_mfma_f32_16x16x32_bf16 v[108:111], v[244:247], v[148:151], v[108:111]
    v_add_u32_e64 v226, s40, v225
    v_cmp_gt_u32 s[72:73], 16, v1
    v_mfma_f32_16x16x32_bf16 v[116:119], v[168:171], v[144:147], v[116:119]
    ds_read_b64_tr_b16 v[168:169], v5 offset:0
    ds_read_b64_tr_b16 v[170:171], v5 offset:256
    v_mfma_f32_16x16x32_bf16 v[116:119], v[172:175], v[148:151], v[116:119]
    ds_read_b64_tr_b16 v[172:173], v5 offset:4096
    ds_read_b64_tr_b16 v[174:175], v5 offset:4352
    v_mfma_f32_16x16x32_bf16 v[124:127], v[176:179], v[144:147], v[124:127]
    ds_read_b64_tr_b16 v[176:177], v6 offset:0
    ds_read_b64_tr_b16 v[178:179], v6 offset:256
    v_mfma_f32_16x16x32_bf16 v[124:127], v[180:183], v[148:151], v[124:127]
    ds_read_b64_tr_b16 v[180:181], v6 offset:4096
    ds_read_b64_tr_b16 v[182:183], v6 offset:4352
    s_waitcnt lgkmcnt(10)
    v_mfma_f32_16x16x32_bf16 v[32:35], v[152:155], v[128:131], v[32:35]
    ds_read_b128 v[144:147], v2 offset:4096
    v_mfma_f32_16x16x32_bf16 v[32:35], v[156:159], v[132:135], v[32:35]
    ds_read_b128 v[148:151], v3 offset:4096
    v_mfma_f32_16x16x32_bf16 v[40:43], v[160:163], v[128:131], v[40:43]
    v_cndmask_b32 v252, v227, v226, s[72:73]
    v_mfma_f32_16x16x32_bf16 v[40:43], v[164:167], v[132:135], v[40:43]
    s_mul_i32 s39, s36, 6
    s_mul_i32 s40, s61, 3
    s_waitcnt lgkmcnt(8)
    v_mfma_f32_16x16x32_bf16 v[48:51], v[168:171], v[128:131], v[48:51]
    s_add_u32 s39, s39, s40
    s_waitcnt lgkmcnt(6)
    v_mfma_f32_16x16x32_bf16 v[48:51], v[172:175], v[132:135], v[48:51]
    s_cmp_lt_u32 s39, 64
    s_cselect_b32 s40, 0x3f80, 0
    s_waitcnt lgkmcnt(4)
    v_mfma_f32_16x16x32_bf16 v[56:59], v[176:179], v[128:131], v[56:59]
    v_mov_b32 v248, s40
    s_waitcnt lgkmcnt(2)
    v_mfma_f32_16x16x32_bf16 v[56:59], v[180:183], v[132:135], v[56:59]
    s_cmp_lt_u32 s39, 63
    s_cselect_b32 s40, 0x3f80, 0
    v_mfma_f32_16x16x32_bf16 v[36:39], v[152:155], v[136:139], v[36:39]
    ds_read_b128 v[128:131], v2 offset:6144
    v_mfma_f32_16x16x32_bf16 v[36:39], v[156:159], v[140:143], v[36:39]
    ds_read_b128 v[132:135], v3 offset:6144
    v_mfma_f32_16x16x32_bf16 v[44:47], v[160:163], v[136:139], v[44:47]
    v_mov_b32 v249, s40
    v_mfma_f32_16x16x32_bf16 v[44:47], v[164:167], v[140:143], v[44:47]
    s_cmp_lt_u32 s39, 62
    s_cselect_b32 s40, 0x3f80, 0
    v_mfma_f32_16x16x32_bf16 v[52:55], v[168:171], v[136:139], v[52:55]
    v_mov_b32 v250, s40
    v_mfma_f32_16x16x32_bf16 v[52:55], v[172:175], v[140:143], v[52:55]
    s_lshr_b32 s40, s39, 1
    s_xor_b32 s40, s40, s39
    v_mfma_f32_16x16x32_bf16 v[60:63], v[176:179], v[136:139], v[60:63]
    s_bfe_u32 s40, s40, 0x10004
    v_mfma_f32_16x16x32_bf16 v[60:63], v[180:183], v[140:143], v[60:63]
    s_and_b32 s62, s39, 31
    s_lshl4_add_u32 s62, s62, s40
    s_waitcnt lgkmcnt(2)
    v_mfma_f32_16x16x32_bf16 v[64:67], v[152:155], v[144:147], v[64:67]
    ds_read_b128 v[136:139], v2 offset:8192
    v_mfma_f32_16x16x32_bf16 v[64:67], v[156:159], v[148:151], v[64:67]
    ds_read_b128 v[140:143], v3 offset:8192
    v_mfma_f32_16x16x32_bf16 v[72:75], v[160:163], v[144:147], v[72:75]
    s_lshl_b32 s62, s62, 13
    v_mfma_f32_16x16x32_bf16 v[72:75], v[164:167], v[148:151], v[72:75]
    s_bitcmp1_b32 s39, 0
    s_cselect_b32 s40, 3072, 0
    v_mfma_f32_16x16x32_bf16 v[80:83], v[168:171], v[144:147], v[80:83]
    s_add_u32 s62, s62, s40
    v_mfma_f32_16x16x32_bf16 v[80:83], v[172:175], v[148:151], v[80:83]
    s_cmp_ge_u32 s39, 64
    s_cselect_b32 s62, 2130706432, s62
    v_mfma_f32_16x16x32_bf16 v[88:91], v[176:179], v[144:147], v[88:91]
    s_add_u32 s39, s39, 1
    v_mfma_f32_16x16x32_bf16 v[88:91], v[180:183], v[148:151], v[88:91]
    s_lshr_b32 s40, s39, 1
    s_xor_b32 s40, s40, s39
    s_waitcnt lgkmcnt(2)
    v_mfma_f32_16x16x32_bf16 v[68:71], v[152:155], v[128:131], v[68:71]
    ds_read_b128 v[144:147], v2 offset:10240
    v_mfma_f32_16x16x32_bf16 v[68:71], v[156:159], v[132:135], v[68:71]
    ds_read_b128 v[148:151], v3 offset:10240
    v_mfma_f32_16x16x32_bf16 v[76:79], v[160:163], v[128:131], v[76:79]
    v_add_u32 v2, 98304, v2
    v_mfma_f32_16x16x32_bf16 v[76:79], v[164:167], v[132:135], v[76:79]
    v_add_u32 v3, 98304, v3
    v_mfma_f32_16x16x32_bf16 v[84:87], v[168:171], v[128:131], v[84:87]
    v_add_u32 v4, 98304, v4
    v_mfma_f32_16x16x32_bf16 v[84:87], v[172:175], v[132:135], v[84:87]
    v_add_u32 v5, 98304, v5
    v_mfma_f32_16x16x32_bf16 v[92:95], v[176:179], v[128:131], v[92:95]
    v_add_u32 v6, 98304, v6
    v_mfma_f32_16x16x32_bf16 v[92:95], v[180:183], v[132:135], v[92:95]
    s_bfe_u32 s40, s40, 0x10004
    s_and_b32 s68, s39, 31
    s_waitcnt lgkmcnt(0)
    s_barrier
    v_mfma_f32_16x16x32_bf16 v[96:99], v[152:155], v[136:139], v[96:99]
    ds_read_b64_tr_b16 v[232:233], v4 offset:0
    ds_read_b64_tr_b16 v[234:235], v4 offset:256
    v_mfma_f32_16x16x32_bf16 v[96:99], v[156:159], v[140:143], v[96:99]
    ds_read_b128 v[128:131], v2 offset:0
    ds_read_b64_tr_b16 v[236:237], v4 offset:4096
    v_mfma_f32_16x16x32_bf16 v[104:107], v[160:163], v[136:139], v[104:107]
    ds_read_b64_tr_b16 v[238:239], v4 offset:4352
    v_mfma_f32_16x16x32_bf16 v[104:107], v[164:167], v[140:143], v[104:107]
    ds_read_b128 v[132:135], v3 offset:0
    v_mfma_f32_16x16x32_bf16 v[112:115], v[168:171], v[136:139], v[112:115]
    ds_read_b64_tr_b16 v[240:241], v4 offset:8192
    v_mfma_f32_16x16x32_bf16 v[112:115], v[172:175], v[140:143], v[112:115]
    ds_read_b64_tr_b16 v[242:243], v4 offset:8448
    v_mfma_f32_16x16x32_bf16 v[120:123], v[176:179], v[136:139], v[120:123]
    ds_read_b64_tr_b16 v[244:245], v4 offset:12288
    v_mfma_f32_16x16x32_bf16 v[120:123], v[180:183], v[140:143], v[120:123]
    ds_read_b64_tr_b16 v[246:247], v4 offset:12544
    v_mfma_f32_16x16x32_bf16 v[100:103], v[152:155], v[144:147], v[100:103]
    ds_read_b128 v[136:139], v2 offset:2048
    ds_read_b128 v[140:143], v3 offset:2048
    v_mfma_f32_16x16x32_bf16 v[100:103], v[156:159], v[148:151], v[100:103]
    s_lshl4_add_u32 s68, s68, s40
    s_lshl_b32 s68, s68, 13
    v_mfma_f32_16x16x32_bf16 v[108:111], v[160:163], v[144:147], v[108:111]
    s_bitcmp1_b32 s39, 0
    v_mfma_f32_16x16x32_bf16 v[108:111], v[164:167], v[148:151], v[108:111]
    s_cselect_b32 s40, 3072, 0
    s_add_u32 s68, s68, s40
    v_mfma_f32_16x16x32_bf16 v[116:119], v[168:171], v[144:147], v[116:119]
    ds_read_b64_tr_b16 v[168:169], v5 offset:0
    ds_read_b64_tr_b16 v[170:171], v5 offset:256
    v_mfma_f32_16x16x32_bf16 v[116:119], v[172:175], v[148:151], v[116:119]
    ds_read_b64_tr_b16 v[172:173], v5 offset:4096
    ds_read_b64_tr_b16 v[174:175], v5 offset:4352
    v_mfma_f32_16x16x32_bf16 v[124:127], v[176:179], v[144:147], v[124:127]
    ds_read_b64_tr_b16 v[176:177], v6 offset:0
    ds_read_b64_tr_b16 v[178:179], v6 offset:256
    v_mfma_f32_16x16x32_bf16 v[124:127], v[180:183], v[148:151], v[124:127]
    ds_read_b64_tr_b16 v[180:181], v6 offset:4096
    ds_read_b64_tr_b16 v[182:183], v6 offset:4352
    s_waitcnt lgkmcnt(10)
    v_mfma_f32_16x16x32_bf16 v[32:35], v[232:235], v[128:131], v[32:35]
    ds_read_b128 v[144:147], v2 offset:4096
    v_mfma_f32_16x16x32_bf16 v[32:35], v[236:239], v[132:135], v[32:35]
    ds_read_b128 v[148:151], v3 offset:4096
    v_mfma_f32_16x16x32_bf16 v[40:43], v[240:243], v[128:131], v[40:43]
    s_cmp_ge_u32 s39, 64
    v_mfma_f32_16x16x32_bf16 v[40:43], v[244:247], v[132:135], v[40:43]
    s_cselect_b32 s68, 2130706432, s68
    s_add_u32 s39, s39, 1
    s_waitcnt lgkmcnt(8)
    v_mfma_f32_16x16x32_bf16 v[48:51], v[168:171], v[128:131], v[48:51]
    s_lshr_b32 s40, s39, 1
    s_waitcnt lgkmcnt(6)
    v_mfma_f32_16x16x32_bf16 v[48:51], v[172:175], v[132:135], v[48:51]
    s_xor_b32 s40, s40, s39
    s_bfe_u32 s40, s40, 0x10004
    s_waitcnt lgkmcnt(4)
    v_mfma_f32_16x16x32_bf16 v[56:59], v[176:179], v[128:131], v[56:59]
    s_and_b32 s69, s39, 31
    s_waitcnt lgkmcnt(2)
    v_mfma_f32_16x16x32_bf16 v[56:59], v[180:183], v[132:135], v[56:59]
    s_lshl4_add_u32 s69, s69, s40
    s_lshl_b32 s69, s69, 13
    v_mfma_f32_16x16x32_bf16 v[36:39], v[232:235], v[136:139], v[36:39]
    ds_read_b128 v[128:131], v2 offset:6144
    v_mfma_f32_16x16x32_bf16 v[36:39], v[236:239], v[140:143], v[36:39]
    ds_read_b128 v[132:135], v3 offset:6144
    v_mfma_f32_16x16x32_bf16 v[44:47], v[240:243], v[136:139], v[44:47]
    s_bitcmp1_b32 s39, 0
    v_mfma_f32_16x16x32_bf16 v[44:47], v[244:247], v[140:143], v[44:47]
    s_cselect_b32 s40, 3072, 0
    s_add_u32 s69, s69, s40
    v_mfma_f32_16x16x32_bf16 v[52:55], v[168:171], v[136:139], v[52:55]
    s_cmp_ge_u32 s39, 64
    v_mfma_f32_16x16x32_bf16 v[52:55], v[172:175], v[140:143], v[52:55]
    s_cselect_b32 s69, 2130706432, s69
    s_lshr_b32 s39, s38, 1
    v_mfma_f32_16x16x32_bf16 v[60:63], v[176:179], v[136:139], v[60:63]
    s_lshl_b32 s39, s39, 14
    v_mfma_f32_16x16x32_bf16 v[60:63], v[180:183], v[140:143], v[60:63]
    s_and_b32 s40, s38, 1
    s_lshl1_add_u32 s40, s40, s60
    s_waitcnt lgkmcnt(2)
    v_mfma_f32_16x16x32_bf16 v[64:67], v[232:235], v[144:147], v[64:67]
    ds_read_b128 v[136:139], v2 offset:8192
    v_mfma_f32_16x16x32_bf16 v[64:67], v[236:239], v[148:151], v[64:67]
    ds_read_b128 v[140:143], v3 offset:8192
    v_mfma_f32_16x16x32_bf16 v[72:75], v[240:243], v[144:147], v[72:75]
    s_mul_i32 s40, s40, 1280
    v_mfma_f32_16x16x32_bf16 v[72:75], v[244:247], v[148:151], v[72:75]
    s_add_u32 s39, s39, s40
    v_lshl_add_u32 v253, v1, 4, s39
    v_mfma_f32_16x16x32_bf16 v[80:83], v[168:171], v[144:147], v[80:83]
    v_mov_b32 v226, s69
    v_mfma_f32_16x16x32_bf16 v[80:83], v[172:175], v[148:151], v[80:83]
    v_mov_b32_e64 v225, s62
    v_cndmask_b32 v226, v226, v225, s[72:73]
    v_mfma_f32_16x16x32_bf16 v[88:91], v[176:179], v[144:147], v[88:91]
    v_mov_b32_e64 v225, s68
    v_mfma_f32_16x16x32_bf16 v[88:91], v[180:183], v[148:151], v[88:91]
    v_cndmask_b32 v226, v226, v225, s[66:67]
    v_lshl_add_u32 v226, v222, 4, v226
    s_waitcnt lgkmcnt(2)
    v_mfma_f32_16x16x32_bf16 v[68:71], v[232:235], v[128:131], v[68:71]
    ds_read_b128 v[144:147], v2 offset:10240
    v_mfma_f32_16x16x32_bf16 v[68:71], v[236:239], v[132:135], v[68:71]
    ds_read_b128 v[148:151], v3 offset:10240
    v_mfma_f32_16x16x32_bf16 v[76:79], v[240:243], v[128:131], v[76:79]
    v_add_u32 v2, -49152, v2
    v_mfma_f32_16x16x32_bf16 v[76:79], v[244:247], v[132:135], v[76:79]
    v_add_u32 v3, -49152, v3
    v_mfma_f32_16x16x32_bf16 v[84:87], v[168:171], v[128:131], v[84:87]
    v_add_u32 v4, -49152, v4
    v_mfma_f32_16x16x32_bf16 v[84:87], v[172:175], v[132:135], v[84:87]
    v_add_u32 v5, -49152, v5
    v_mfma_f32_16x16x32_bf16 v[92:95], v[176:179], v[128:131], v[92:95]
    v_add_u32 v6, -49152, v6
    v_mfma_f32_16x16x32_bf16 v[92:95], v[180:183], v[132:135], v[92:95]
    v_add_u32 v226, s39, v226
    v_cmp_gt_u32_e64 vcc, 48, v1
    s_waitcnt lgkmcnt(0)
    s_barrier
    v_mfma_f32_16x16x32_bf16 v[96:99], v[232:235], v[136:139], v[96:99]
    ds_read_b64_tr_b16 v[152:153], v4 offset:0
    ds_read_b64_tr_b16 v[154:155], v4 offset:256
    v_mfma_f32_16x16x32_bf16 v[96:99], v[236:239], v[140:143], v[96:99]
    ds_read_b128 v[128:131], v2 offset:0
    ds_read_b64_tr_b16 v[156:157], v4 offset:4096
    v_mfma_f32_16x16x32_bf16 v[104:107], v[240:243], v[136:139], v[104:107]
    ds_read_b64_tr_b16 v[158:159], v4 offset:4352
    v_mfma_f32_16x16x32_bf16 v[104:107], v[244:247], v[140:143], v[104:107]
    ds_read_b128 v[132:135], v3 offset:0
    v_mfma_f32_16x16x32_bf16 v[112:115], v[168:171], v[136:139], v[112:115]
    ds_read_b64_tr_b16 v[160:161], v4 offset:8192
    v_mfma_f32_16x16x32_bf16 v[112:115], v[172:175], v[140:143], v[112:115]
    ds_read_b64_tr_b16 v[162:163], v4 offset:8448
    v_mfma_f32_16x16x32_bf16 v[120:123], v[176:179], v[136:139], v[120:123]
    ds_read_b64_tr_b16 v[164:165], v4 offset:12288
    v_mfma_f32_16x16x32_bf16 v[120:123], v[180:183], v[140:143], v[120:123]
    ds_read_b64_tr_b16 v[166:167], v4 offset:12544
    v_mfma_f32_16x16x32_bf16 v[100:103], v[232:235], v[144:147], v[100:103]
    ds_read_b128 v[136:139], v2 offset:2048
    ds_read_b128 v[140:143], v3 offset:2048
    v_mfma_f32_16x16x32_bf16 v[100:103], v[236:239], v[148:151], v[100:103]
    v_cndmask_b32 v254, v227, v226, vcc
    v_lshrrev_b32 v224, 1, v219
    v_mfma_f32_16x16x32_bf16 v[108:111], v[240:243], v[144:147], v[108:111]
    v_lshl_add_u32 v224, v220, 1, v224
    v_mfma_f32_16x16x32_bf16 v[108:111], v[244:247], v[148:151], v[108:111]
    v_mul_u32_u24 v225, 40, v218
    v_add_u32 v225, s41, v225
    v_mfma_f32_16x16x32_bf16 v[116:119], v[168:171], v[144:147], v[116:119]
    ds_read_b64_tr_b16 v[168:169], v5 offset:0
    ds_read_b64_tr_b16 v[170:171], v5 offset:256
    v_mfma_f32_16x16x32_bf16 v[116:119], v[172:175], v[148:151], v[116:119]
    ds_read_b64_tr_b16 v[172:173], v5 offset:4096
    ds_read_b64_tr_b16 v[174:175], v5 offset:4352
    v_mfma_f32_16x16x32_bf16 v[124:127], v[176:179], v[144:147], v[124:127]
    ds_read_b64_tr_b16 v[176:177], v6 offset:0
    ds_read_b64_tr_b16 v[178:179], v6 offset:256
    v_mfma_f32_16x16x32_bf16 v[124:127], v[180:183], v[148:151], v[124:127]
    ds_read_b64_tr_b16 v[180:181], v6 offset:4096
    ds_read_b64_tr_b16 v[182:183], v6 offset:4352
    s_waitcnt lgkmcnt(10)
    v_mfma_f32_16x16x32_bf16 v[32:35], v[152:155], v[128:131], v[32:35]
    ds_read_b128 v[144:147], v2 offset:4096
    v_mfma_f32_16x16x32_bf16 v[32:35], v[156:159], v[132:135], v[32:35]
    ds_read_b128 v[148:151], v3 offset:4096
    v_mfma_f32_16x16x32_bf16 v[40:43], v[160:163], v[128:131], v[40:43]
    v_lshl_add_u32 v224, v224, 3, v225
    v_mfma_f32_16x16x32_bf16 v[40:43], v[164:167], v[132:135], v[40:43]
    v_mul_u32_u24 v227, 160, v217
    v_add_u32_e64 v226, v224, v227
    s_waitcnt lgkmcnt(8)
    v_mfma_f32_16x16x32_bf16 v[48:51], v[168:171], v[128:131], v[48:51]
    v_add_u32 v227, v225, v227
    s_waitcnt lgkmcnt(6)
    v_mfma_f32_16x16x32_bf16 v[48:51], v[172:175], v[132:135], v[48:51]
    s_waitcnt vmcnt(0)
    ds_read_b64_tr_b16 v[184:185], v226 offset:0
    s_waitcnt lgkmcnt(5)
    v_mfma_f32_16x16x32_bf16 v[56:59], v[176:179], v[128:131], v[56:59]
    ds_read_b64_tr_b16 v[186:187], v226 offset:320
    s_waitcnt lgkmcnt(4)
    v_mfma_f32_16x16x32_bf16 v[56:59], v[180:183], v[132:135], v[56:59]
    ds_read_b64_tr_b16 v[188:189], v224 offset:640
    ds_read_b64_tr_b16 v[192:193], v227 offset:32
    v_mfma_f32_16x16x32_bf16 v[36:39], v[152:155], v[136:139], v[36:39]
    ds_read_b128 v[128:131], v2 offset:6144
    v_mfma_f32_16x16x32_bf16 v[36:39], v[156:159], v[140:143], v[36:39]
    ds_read_b128 v[132:135], v3 offset:6144
    v_mfma_f32_16x16x32_bf16 v[44:47], v[160:163], v[136:139], v[44:47]
    ds_read_b64_tr_b16 v[194:195], v227 offset:352
    v_mfma_f32_16x16x32_bf16 v[44:47], v[164:167], v[140:143], v[44:47]
    ds_read_b64_tr_b16 v[196:197], v225 offset:672
    ds_read_b64_tr_b16 v[200:201], v226 offset:1024
    v_mfma_f32_16x16x32_bf16 v[52:55], v[168:171], v[136:139], v[52:55]
    ds_read_b64_tr_b16 v[202:203], v226 offset:1344
    v_mfma_f32_16x16x32_bf16 v[52:55], v[172:175], v[140:143], v[52:55]
    ds_read_b64_tr_b16 v[204:205], v224 offset:1664
    ds_read_b64_tr_b16 v[208:209], v227 offset:1056
    v_mfma_f32_16x16x32_bf16 v[60:63], v[176:179], v[136:139], v[60:63]
    ds_read_b64_tr_b16 v[210:211], v227 offset:1376
    v_mfma_f32_16x16x32_bf16 v[60:63], v[180:183], v[140:143], v[60:63]
    ds_read_b64_tr_b16 v[212:213], v225 offset:1696
    v_bfe_u32 v29, v1, 2, 1
    s_waitcnt lgkmcnt(10)
    v_mfma_f32_16x16x32_bf16 v[64:67], v[152:155], v[144:147], v[64:67]
    ds_read_b128 v[136:139], v2 offset:8192
    v_mfma_f32_16x16x32_bf16 v[64:67], v[156:159], v[148:151], v[64:67]
    ds_read_b128 v[140:143], v3 offset:8192
    v_mfma_f32_16x16x32_bf16 v[72:75], v[160:163], v[144:147], v[72:75]
    v_mov_b32 v30, 0x80008000
    v_mfma_f32_16x16x32_bf16 v[72:75], v[164:167], v[148:151], v[72:75]
    v_mul_lo_u32 v29, v29, v30
    v_xor_b32_e64 v184, v29, v184
    v_mfma_f32_16x16x32_bf16 v[80:83], v[168:171], v[144:147], v[80:83]
    v_xor_b32_e64 v185, v29, v185
    v_mfma_f32_16x16x32_bf16 v[80:83], v[172:175], v[148:151], v[80:83]
    v_xor_b32 v186, v29, v186
    v_xor_b32 v187, v29, v187
    v_mfma_f32_16x16x32_bf16 v[88:91], v[176:179], v[144:147], v[88:91]
    v_xor_b32_e64 v188, v29, v188
    v_mfma_f32_16x16x32_bf16 v[88:91], v[180:183], v[148:151], v[88:91]
    v_xor_b32_e64 v189, v29, v189
    v_cndmask_b32 v188, v188, 0, s[66:67]
    s_waitcnt lgkmcnt(2)
    v_mfma_f32_16x16x32_bf16 v[68:71], v[152:155], v[128:131], v[68:71]
    ds_read_b128 v[144:147], v2 offset:10240
    v_mfma_f32_16x16x32_bf16 v[68:71], v[156:159], v[132:135], v[68:71]
    ds_read_b128 v[148:151], v3 offset:10240
    v_mfma_f32_16x16x32_bf16 v[76:79], v[160:163], v[128:131], v[76:79]
    v_add_u32 v2, -49152, v2
    v_mfma_f32_16x16x32_bf16 v[76:79], v[164:167], v[132:135], v[76:79]
    v_add_u32 v3, -49152, v3
    v_mfma_f32_16x16x32_bf16 v[84:87], v[168:171], v[128:131], v[84:87]
    v_add_u32 v4, -49152, v4
    v_mfma_f32_16x16x32_bf16 v[84:87], v[172:175], v[132:135], v[84:87]
    v_add_u32 v5, -49152, v5
    v_mfma_f32_16x16x32_bf16 v[92:95], v[176:179], v[128:131], v[92:95]
    v_add_u32 v6, -49152, v6
    v_mfma_f32_16x16x32_bf16 v[92:95], v[180:183], v[132:135], v[92:95]
    v_cndmask_b32 v189, v189, 0, s[66:67]
    v_mov_b32 v190, 0
    s_waitcnt lgkmcnt(0)
    s_barrier
    v_mfma_f32_16x16x32_bf16 v[96:99], v[152:155], v[136:139], v[96:99]
    ds_read_b64_tr_b16 v[232:233], v4 offset:0
    ds_read_b64_tr_b16 v[234:235], v4 offset:256
    v_mfma_f32_16x16x32_bf16 v[96:99], v[156:159], v[140:143], v[96:99]
    ds_read_b128 v[128:131], v2 offset:0
    ds_read_b64_tr_b16 v[236:237], v4 offset:4096
    v_mfma_f32_16x16x32_bf16 v[104:107], v[160:163], v[136:139], v[104:107]
    ds_read_b64_tr_b16 v[238:239], v4 offset:4352
    v_mfma_f32_16x16x32_bf16 v[104:107], v[164:167], v[140:143], v[104:107]
    ds_read_b128 v[132:135], v3 offset:0
    v_mfma_f32_16x16x32_bf16 v[112:115], v[168:171], v[136:139], v[112:115]
    ds_read_b64_tr_b16 v[240:241], v4 offset:8192
    v_mfma_f32_16x16x32_bf16 v[112:115], v[172:175], v[140:143], v[112:115]
    ds_read_b64_tr_b16 v[242:243], v4 offset:8448
    v_mfma_f32_16x16x32_bf16 v[120:123], v[176:179], v[136:139], v[120:123]
    ds_read_b64_tr_b16 v[244:245], v4 offset:12288
    v_mfma_f32_16x16x32_bf16 v[120:123], v[180:183], v[140:143], v[120:123]
    ds_read_b64_tr_b16 v[246:247], v4 offset:12544
    v_mfma_f32_16x16x32_bf16 v[100:103], v[152:155], v[144:147], v[100:103]
    ds_read_b128 v[136:139], v2 offset:2048
    ds_read_b128 v[140:143], v3 offset:2048
    v_mfma_f32_16x16x32_bf16 v[100:103], v[156:159], v[148:151], v[100:103]
    v_mov_b32 v191, 0
    v_xor_b32 v192, v29, v192
    v_mfma_f32_16x16x32_bf16 v[108:111], v[160:163], v[144:147], v[108:111]
    v_xor_b32_e64 v193, v29, v193
    v_mfma_f32_16x16x32_bf16 v[108:111], v[164:167], v[148:151], v[108:111]
    v_xor_b32 v194, v29, v194
    v_xor_b32 v195, v29, v195
    v_mfma_f32_16x16x32_bf16 v[116:119], v[168:171], v[144:147], v[116:119]
    ds_read_b64_tr_b16 v[168:169], v5 offset:0
    ds_read_b64_tr_b16 v[170:171], v5 offset:256
    v_mfma_f32_16x16x32_bf16 v[116:119], v[172:175], v[148:151], v[116:119]
    ds_read_b64_tr_b16 v[172:173], v5 offset:4096
    ds_read_b64_tr_b16 v[174:175], v5 offset:4352
    v_mfma_f32_16x16x32_bf16 v[124:127], v[176:179], v[144:147], v[124:127]
    ds_read_b64_tr_b16 v[176:177], v6 offset:0
    ds_read_b64_tr_b16 v[178:179], v6 offset:256
    v_mfma_f32_16x16x32_bf16 v[124:127], v[180:183], v[148:151], v[124:127]
    ds_read_b64_tr_b16 v[180:181], v6 offset:4096
    ds_read_b64_tr_b16 v[182:183], v6 offset:4352
    s_waitcnt lgkmcnt(10)
    v_mfma_f32_16x16x32_bf16 v[32:35], v[232:235], v[128:131], v[32:35]
    ds_read_b128 v[144:147], v2 offset:4096
    v_mfma_f32_16x16x32_bf16 v[32:35], v[236:239], v[132:135], v[32:35]
    ds_read_b128 v[148:151], v3 offset:4096
    v_mfma_f32_16x16x32_bf16 v[40:43], v[240:243], v[128:131], v[40:43]
    v_xor_b32 v196, v29, v196
    v_mfma_f32_16x16x32_bf16 v[40:43], v[244:247], v[132:135], v[40:43]
    v_xor_b32_e64 v197, v29, v197
    v_cndmask_b32 v196, v196, 0, s[66:67]
    s_waitcnt lgkmcnt(8)
    v_mfma_f32_16x16x32_bf16 v[48:51], v[168:171], v[128:131], v[48:51]
    v_cndmask_b32 v197, v197, 0, s[66:67]
    s_waitcnt lgkmcnt(6)
    v_mfma_f32_16x16x32_bf16 v[48:51], v[172:175], v[132:135], v[48:51]
    v_mov_b32_e64 v198, 0
    v_mov_b32 v199, 0
    s_waitcnt lgkmcnt(4)
    v_mfma_f32_16x16x32_bf16 v[56:59], v[176:179], v[128:131], v[56:59]
    v_xor_b32 v200, v29, v200
    s_waitcnt lgkmcnt(2)
    v_mfma_f32_16x16x32_bf16 v[56:59], v[180:183], v[132:135], v[56:59]
    v_xor_b32 v201, v29, v201
    v_xor_b32 v202, v29, v202
    v_mfma_f32_16x16x32_bf16 v[36:39], v[232:235], v[136:139], v[36:39]
    ds_read_b128 v[128:131], v2 offset:6144
    v_mfma_f32_16x16x32_bf16 v[36:39], v[236:239], v[140:143], v[36:39]
    ds_read_b128 v[132:135], v3 offset:6144
    v_mfma_f32_16x16x32_bf16 v[44:47], v[240:243], v[136:139], v[44:47]
    v_xor_b32_e64 v203, v29, v203
    v_mfma_f32_16x16x32_bf16 v[44:47], v[244:247], v[140:143], v[44:47]
    v_xor_b32 v204, v29, v204
    v_xor_b32 v205, v29, v205
    v_mfma_f32_16x16x32_bf16 v[52:55], v[168:171], v[136:139], v[52:55]
    v_cndmask_b32 v204, 0, v204, s[66:67]
    v_mfma_f32_16x16x32_bf16 v[52:55], v[172:175], v[140:143], v[52:55]
    v_cndmask_b32 v205, 0, v205, s[66:67]
    v_mov_b32_e64 v206, 0
    v_mfma_f32_16x16x32_bf16 v[60:63], v[176:179], v[136:139], v[60:63]
    v_mov_b32_e64 v207, 0
    v_mfma_f32_16x16x32_bf16 v[60:63], v[180:183], v[140:143], v[60:63]
    v_xor_b32_e64 v208, v29, v208
    v_xor_b32 v209, v29, v209
    s_waitcnt lgkmcnt(2)
    v_mfma_f32_16x16x32_bf16 v[64:67], v[232:235], v[144:147], v[64:67]
    ds_read_b128 v[136:139], v2 offset:8192
    v_mfma_f32_16x16x32_bf16 v[64:67], v[236:239], v[148:151], v[64:67]
    ds_read_b128 v[140:143], v3 offset:8192
    v_mfma_f32_16x16x32_bf16 v[72:75], v[240:243], v[144:147], v[72:75]
    v_xor_b32_e64 v210, v29, v210
    v_mfma_f32_16x16x32_bf16 v[72:75], v[244:247], v[148:151], v[72:75]
    v_xor_b32 v211, v29, v211
    v_xor_b32 v212, v29, v212
    v_mfma_f32_16x16x32_bf16 v[80:83], v[168:171], v[144:147], v[80:83]
    v_xor_b32_e64 v213, v29, v213
    v_mfma_f32_16x16x32_bf16 v[80:83], v[172:175], v[148:151], v[80:83]
    v_cndmask_b32 v212, 0, v212, s[66:67]
    v_cndmask_b32 v213, 0, v213, s[66:67]
    v_mfma_f32_16x16x32_bf16 v[88:91], v[176:179], v[144:147], v[88:91]
    v_mov_b32_e64 v214, 0
    v_mfma_f32_16x16x32_bf16 v[88:91], v[180:183], v[148:151], v[88:91]
    v_mov_b32_e64 v215, 0
    s_mov_b32 s64, 0x3fb8aa3b
    s_waitcnt lgkmcnt(2)
    v_mfma_f32_16x16x32_bf16 v[68:71], v[232:235], v[128:131], v[68:71]
    ds_read_b128 v[144:147], v2 offset:10240
    v_mfma_f32_16x16x32_bf16 v[68:71], v[236:239], v[132:135], v[68:71]
    ds_read_b128 v[148:151], v3 offset:10240
    v_mfma_f32_16x16x32_bf16 v[76:79], v[240:243], v[128:131], v[76:79]
    v_add_u32 v2, 98304, v2
    v_mfma_f32_16x16x32_bf16 v[76:79], v[244:247], v[132:135], v[76:79]
    v_add_u32 v3, 98304, v3
    v_mfma_f32_16x16x32_bf16 v[84:87], v[168:171], v[128:131], v[84:87]
    v_add_u32 v4, 98304, v4
    v_mfma_f32_16x16x32_bf16 v[84:87], v[172:175], v[132:135], v[84:87]
    v_add_u32 v5, 98304, v5
    v_mfma_f32_16x16x32_bf16 v[92:95], v[176:179], v[128:131], v[92:95]
    v_add_u32 v6, 98304, v6
    v_mfma_f32_16x16x32_bf16 v[92:95], v[180:183], v[132:135], v[92:95]
    v_mov_b32 v31, 0
    s_waitcnt lgkmcnt(0)
    s_barrier
    v_mfma_f32_16x16x32_bf16 v[96:99], v[232:235], v[136:139], v[96:99]
    ds_read_b64_tr_b16 v[152:153], v4 offset:0
    ds_read_b64_tr_b16 v[154:155], v4 offset:256
    v_mfma_f32_16x16x32_bf16 v[96:99], v[236:239], v[140:143], v[96:99]
    ds_read_b128 v[128:131], v2 offset:0
    ds_read_b64_tr_b16 v[156:157], v4 offset:4096
    v_mfma_f32_16x16x32_bf16 v[104:107], v[240:243], v[136:139], v[104:107]
    ds_read_b64_tr_b16 v[158:159], v4 offset:4352
    v_mfma_f32_16x16x32_bf16 v[104:107], v[244:247], v[140:143], v[104:107]
    ds_read_b128 v[132:135], v3 offset:0
    v_mfma_f32_16x16x32_bf16 v[112:115], v[168:171], v[136:139], v[112:115]
    ds_read_b64_tr_b16 v[160:161], v4 offset:8192
    v_mfma_f32_16x16x32_bf16 v[112:115], v[172:175], v[140:143], v[112:115]
    ds_read_b64_tr_b16 v[162:163], v4 offset:8448
    v_mfma_f32_16x16x32_bf16 v[120:123], v[176:179], v[136:139], v[120:123]
    ds_read_b64_tr_b16 v[164:165], v4 offset:12288
    v_mfma_f32_16x16x32_bf16 v[120:123], v[180:183], v[140:143], v[120:123]
    ds_read_b64_tr_b16 v[166:167], v4 offset:12544
    v_mfma_f32_16x16x32_bf16 v[100:103], v[232:235], v[144:147], v[100:103]
    ds_read_b128 v[136:139], v2 offset:2048
    ds_read_b128 v[140:143], v3 offset:2048
    v_mfma_f32_16x16x32_bf16 v[100:103], v[236:239], v[148:151], v[100:103]
    v_mfma_f32_16x16x32_bf16 v[108:111], v[240:243], v[144:147], v[108:111]
    v_mfma_f32_16x16x32_bf16 v[108:111], v[244:247], v[148:151], v[108:111]
    v_mfma_f32_16x16x32_bf16 v[116:119], v[168:171], v[144:147], v[116:119]
    ds_read_b64_tr_b16 v[168:169], v5 offset:0
    ds_read_b64_tr_b16 v[170:171], v5 offset:256
    v_mfma_f32_16x16x32_bf16 v[116:119], v[172:175], v[148:151], v[116:119]
    ds_read_b64_tr_b16 v[172:173], v5 offset:4096
    ds_read_b64_tr_b16 v[174:175], v5 offset:4352
    v_mfma_f32_16x16x32_bf16 v[124:127], v[176:179], v[144:147], v[124:127]
    ds_read_b64_tr_b16 v[176:177], v6 offset:0
    ds_read_b64_tr_b16 v[178:179], v6 offset:256
    v_mfma_f32_16x16x32_bf16 v[124:127], v[180:183], v[148:151], v[124:127]
    ds_read_b64_tr_b16 v[180:181], v6 offset:4096
    ds_read_b64_tr_b16 v[182:183], v6 offset:4352
    s_waitcnt lgkmcnt(10)
    v_mfma_f32_16x16x32_bf16 v[32:35], v[152:155], v[128:131], v[32:35]
    ds_read_b128 v[144:147], v2 offset:4096
    v_mfma_f32_16x16x32_bf16 v[32:35], v[156:159], v[132:135], v[32:35]
    ds_read_b128 v[148:151], v3 offset:4096
    v_mfma_f32_16x16x32_bf16 v[40:43], v[160:163], v[128:131], v[40:43]
    v_mfma_f32_16x16x32_bf16 v[40:43], v[164:167], v[132:135], v[40:43]
    s_waitcnt lgkmcnt(8)
    v_mfma_f32_16x16x32_bf16 v[48:51], v[168:171], v[128:131], v[48:51]
    s_waitcnt lgkmcnt(6)
    v_mfma_f32_16x16x32_bf16 v[48:51], v[172:175], v[132:135], v[48:51]
    s_waitcnt lgkmcnt(4)
    v_mfma_f32_16x16x32_bf16 v[56:59], v[176:179], v[128:131], v[56:59]
    s_waitcnt lgkmcnt(2)
    v_mfma_f32_16x16x32_bf16 v[56:59], v[180:183], v[132:135], v[56:59]
    v_mfma_f32_16x16x32_bf16 v[36:39], v[152:155], v[136:139], v[36:39]
    ds_read_b128 v[128:131], v2 offset:6144
    v_mfma_f32_16x16x32_bf16 v[36:39], v[156:159], v[140:143], v[36:39]
    ds_read_b128 v[132:135], v3 offset:6144
    v_mfma_f32_16x16x32_bf16 v[44:47], v[160:163], v[136:139], v[44:47]
    v_mfma_f32_16x16x32_bf16 v[44:47], v[164:167], v[140:143], v[44:47]
    v_mfma_f32_16x16x32_bf16 v[52:55], v[168:171], v[136:139], v[52:55]
    v_mfma_f32_16x16x32_bf16 v[52:55], v[172:175], v[140:143], v[52:55]
    v_mfma_f32_16x16x32_bf16 v[60:63], v[176:179], v[136:139], v[60:63]
    v_mfma_f32_16x16x32_bf16 v[60:63], v[180:183], v[140:143], v[60:63]
    s_waitcnt lgkmcnt(2)
    v_mfma_f32_16x16x32_bf16 v[64:67], v[152:155], v[144:147], v[64:67]
    ds_read_b128 v[136:139], v2 offset:8192
    v_mfma_f32_16x16x32_bf16 v[64:67], v[156:159], v[148:151], v[64:67]
    ds_read_b128 v[140:143], v3 offset:8192
    v_mfma_f32_16x16x32_bf16 v[72:75], v[160:163], v[144:147], v[72:75]
    v_mfma_f32_16x16x32_bf16 v[72:75], v[164:167], v[148:151], v[72:75]
    v_mfma_f32_16x16x32_bf16 v[80:83], v[168:171], v[144:147], v[80:83]
    v_mfma_f32_16x16x32_bf16 v[80:83], v[172:175], v[148:151], v[80:83]
    v_mfma_f32_16x16x32_bf16 v[88:91], v[176:179], v[144:147], v[88:91]
    v_mfma_f32_16x16x32_bf16 v[88:91], v[180:183], v[148:151], v[88:91]
    s_waitcnt lgkmcnt(2)
    v_mfma_f32_16x16x32_bf16 v[68:71], v[152:155], v[128:131], v[68:71]
    ds_read_b128 v[144:147], v2 offset:10240
    v_mfma_f32_16x16x32_bf16 v[68:71], v[156:159], v[132:135], v[68:71]
    ds_read_b128 v[148:151], v3 offset:10240
    v_mfma_f32_16x16x32_bf16 v[76:79], v[160:163], v[128:131], v[76:79]
    v_add_u32 v2, -49152, v2
    v_mfma_f32_16x16x32_bf16 v[76:79], v[164:167], v[132:135], v[76:79]
    v_add_u32 v3, -49152, v3
    v_mfma_f32_16x16x32_bf16 v[84:87], v[168:171], v[128:131], v[84:87]
    v_add_u32 v4, -49152, v4
    v_mfma_f32_16x16x32_bf16 v[84:87], v[172:175], v[132:135], v[84:87]
    v_add_u32 v5, -49152, v5
    v_mfma_f32_16x16x32_bf16 v[92:95], v[176:179], v[128:131], v[92:95]
    v_add_u32 v6, -49152, v6
    v_mfma_f32_16x16x32_bf16 v[92:95], v[180:183], v[132:135], v[92:95]
    s_waitcnt lgkmcnt(0)
    s_barrier
    v_mfma_f32_16x16x32_bf16 v[96:99], v[152:155], v[136:139], v[96:99]
    ds_read_b64_tr_b16 v[232:233], v4 offset:0
    ds_read_b64_tr_b16 v[234:235], v4 offset:256
    v_mfma_f32_16x16x32_bf16 v[96:99], v[156:159], v[140:143], v[96:99]
    ds_read_b128 v[128:131], v2 offset:0
    ds_read_b64_tr_b16 v[236:237], v4 offset:4096
    v_mfma_f32_16x16x32_bf16 v[104:107], v[160:163], v[136:139], v[104:107]
    ds_read_b64_tr_b16 v[238:239], v4 offset:4352
    v_mfma_f32_16x16x32_bf16 v[104:107], v[164:167], v[140:143], v[104:107]
    ds_read_b128 v[132:135], v3 offset:0
    v_mfma_f32_16x16x32_bf16 v[112:115], v[168:171], v[136:139], v[112:115]
    ds_read_b64_tr_b16 v[240:241], v4 offset:8192
    v_mfma_f32_16x16x32_bf16 v[112:115], v[172:175], v[140:143], v[112:115]
    ds_read_b64_tr_b16 v[242:243], v4 offset:8448
    v_mfma_f32_16x16x32_bf16 v[120:123], v[176:179], v[136:139], v[120:123]
    ds_read_b64_tr_b16 v[244:245], v4 offset:12288
    v_mfma_f32_16x16x32_bf16 v[120:123], v[180:183], v[140:143], v[120:123]
    ds_read_b64_tr_b16 v[246:247], v4 offset:12544
    v_mfma_f32_16x16x32_bf16 v[100:103], v[152:155], v[144:147], v[100:103]
    ds_read_b128 v[136:139], v2 offset:2048
    ds_read_b128 v[140:143], v3 offset:2048
    v_mfma_f32_16x16x32_bf16 v[100:103], v[156:159], v[148:151], v[100:103]
    v_mfma_f32_16x16x32_bf16 v[108:111], v[160:163], v[144:147], v[108:111]
    v_mfma_f32_16x16x32_bf16 v[108:111], v[164:167], v[148:151], v[108:111]
    v_mfma_f32_16x16x32_bf16 v[116:119], v[168:171], v[144:147], v[116:119]
    ds_read_b64_tr_b16 v[168:169], v5 offset:0
    ds_read_b64_tr_b16 v[170:171], v5 offset:256
    v_mfma_f32_16x16x32_bf16 v[116:119], v[172:175], v[148:151], v[116:119]
    ds_read_b64_tr_b16 v[172:173], v5 offset:4096
    ds_read_b64_tr_b16 v[174:175], v5 offset:4352
    v_mfma_f32_16x16x32_bf16 v[124:127], v[176:179], v[144:147], v[124:127]
    ds_read_b64_tr_b16 v[176:177], v6 offset:0
    ds_read_b64_tr_b16 v[178:179], v6 offset:256
    v_mfma_f32_16x16x32_bf16 v[124:127], v[180:183], v[148:151], v[124:127]
    ds_read_b64_tr_b16 v[180:181], v6 offset:4096
    ds_read_b64_tr_b16 v[182:183], v6 offset:4352
    s_waitcnt lgkmcnt(10)
    v_mfma_f32_16x16x32_bf16 v[32:35], v[232:235], v[128:131], v[32:35]
    ds_read_b128 v[144:147], v2 offset:4096
    v_mfma_f32_16x16x32_bf16 v[32:35], v[236:239], v[132:135], v[32:35]
    ds_read_b128 v[148:151], v3 offset:4096
    v_mfma_f32_16x16x32_bf16 v[40:43], v[240:243], v[128:131], v[40:43]
    v_mfma_f32_16x16x32_bf16 v[40:43], v[244:247], v[132:135], v[40:43]
    s_waitcnt lgkmcnt(8)
    v_mfma_f32_16x16x32_bf16 v[48:51], v[168:171], v[128:131], v[48:51]
    s_waitcnt lgkmcnt(6)
    v_mfma_f32_16x16x32_bf16 v[48:51], v[172:175], v[132:135], v[48:51]
    s_waitcnt lgkmcnt(4)
    v_mfma_f32_16x16x32_bf16 v[56:59], v[176:179], v[128:131], v[56:59]
    s_waitcnt lgkmcnt(2)
    v_mfma_f32_16x16x32_bf16 v[56:59], v[180:183], v[132:135], v[56:59]
    v_mfma_f32_16x16x32_bf16 v[36:39], v[232:235], v[136:139], v[36:39]
    ds_read_b128 v[128:131], v2 offset:6144
    v_mfma_f32_16x16x32_bf16 v[36:39], v[236:239], v[140:143], v[36:39]
    ds_read_b128 v[132:135], v3 offset:6144
    v_mfma_f32_16x16x32_bf16 v[44:47], v[240:243], v[136:139], v[44:47]
    v_mfma_f32_16x16x32_bf16 v[44:47], v[244:247], v[140:143], v[44:47]
    v_mfma_f32_16x16x32_bf16 v[52:55], v[168:171], v[136:139], v[52:55]
    v_mfma_f32_16x16x32_bf16 v[52:55], v[172:175], v[140:143], v[52:55]
    v_mfma_f32_16x16x32_bf16 v[60:63], v[176:179], v[136:139], v[60:63]
    v_mfma_f32_16x16x32_bf16 v[60:63], v[180:183], v[140:143], v[60:63]
    s_waitcnt lgkmcnt(2)
    v_mfma_f32_16x16x32_bf16 v[64:67], v[232:235], v[144:147], v[64:67]
    ds_read_b128 v[136:139], v2 offset:8192
    v_mfma_f32_16x16x32_bf16 v[64:67], v[236:239], v[148:151], v[64:67]
    ds_read_b128 v[140:143], v3 offset:8192
    v_mfma_f32_16x16x32_bf16 v[72:75], v[240:243], v[144:147], v[72:75]
    v_mfma_f32_16x16x32_bf16 v[72:75], v[244:247], v[148:151], v[72:75]
    v_mfma_f32_16x16x32_bf16 v[80:83], v[168:171], v[144:147], v[80:83]
    v_mfma_f32_16x16x32_bf16 v[80:83], v[172:175], v[148:151], v[80:83]
    v_mfma_f32_16x16x32_bf16 v[88:91], v[176:179], v[144:147], v[88:91]
    v_mfma_f32_16x16x32_bf16 v[88:91], v[180:183], v[148:151], v[88:91]
    s_waitcnt lgkmcnt(2)
    v_mfma_f32_16x16x32_bf16 v[68:71], v[232:235], v[128:131], v[68:71]
    ds_read_b128 v[144:147], v2 offset:10240
    v_mfma_f32_16x16x32_bf16 v[68:71], v[236:239], v[132:135], v[68:71]
    ds_read_b128 v[148:151], v3 offset:10240
    v_mfma_f32_16x16x32_bf16 v[76:79], v[240:243], v[128:131], v[76:79]
    v_add_u32 v2, -49152, v2
    v_mfma_f32_16x16x32_bf16 v[76:79], v[244:247], v[132:135], v[76:79]
    v_add_u32 v3, -49152, v3
    v_mfma_f32_16x16x32_bf16 v[84:87], v[168:171], v[128:131], v[84:87]
    v_add_u32 v4, -49152, v4
    v_mfma_f32_16x16x32_bf16 v[84:87], v[172:175], v[132:135], v[84:87]
    v_add_u32 v5, -49152, v5
    v_mfma_f32_16x16x32_bf16 v[92:95], v[176:179], v[128:131], v[92:95]
    v_add_u32 v6, -49152, v6
    v_mfma_f32_16x16x32_bf16 v[92:95], v[180:183], v[132:135], v[92:95]
    s_waitcnt lgkmcnt(2)
    v_mfma_f32_16x16x32_bf16 v[96:99], v[232:235], v[136:139], v[96:99]
    v_mfma_f32_16x16x32_bf16 v[96:99], v[236:239], v[140:143], v[96:99]
    v_mfma_f32_16x16x32_bf16 v[104:107], v[240:243], v[136:139], v[104:107]
    v_mfma_f32_16x16x32_bf16 v[104:107], v[244:247], v[140:143], v[104:107]
    v_mfma_f32_16x16x32_bf16 v[112:115], v[168:171], v[136:139], v[112:115]
    v_mfma_f32_16x16x32_bf16 v[112:115], v[172:175], v[140:143], v[112:115]
    v_mfma_f32_16x16x32_bf16 v[120:123], v[176:179], v[136:139], v[120:123]
    v_mfma_f32_16x16x32_bf16 v[120:123], v[180:183], v[140:143], v[120:123]
    s_waitcnt lgkmcnt(0)
    s_barrier
    v_mfma_f32_16x16x32_bf16 v[100:103], v[232:235], v[144:147], v[100:103]
    ds_read_b64_tr_b16 v[152:153], v4 offset:0
    ds_read_b64_tr_b16 v[154:155], v4 offset:256
    ds_read_b128 v[128:131], v2 offset:0
    v_mfma_f32_16x16x32_bf16 v[100:103], v[236:239], v[148:151], v[100:103]
    ds_read_b64_tr_b16 v[156:157], v4 offset:4096
    ds_read_b64_tr_b16 v[158:159], v4 offset:4352
    ds_read_b128 v[132:135], v3 offset:0
    v_mfma_f32_16x16x32_bf16 v[108:111], v[240:243], v[144:147], v[108:111]
    ds_read_b64_tr_b16 v[160:161], v4 offset:8192
    ds_read_b64_tr_b16 v[162:163], v4 offset:8448
    ds_read_b64_tr_b16 v[164:165], v4 offset:12288
    v_mfma_f32_16x16x32_bf16 v[108:111], v[244:247], v[148:151], v[108:111]
    ds_read_b64_tr_b16 v[166:167], v4 offset:12544
    ds_read_b128 v[136:139], v2 offset:2048
    ds_read_b128 v[140:143], v3 offset:2048
    v_mfma_f32_16x16x32_bf16 v[116:119], v[168:171], v[144:147], v[116:119]
    ds_read_b64_tr_b16 v[168:169], v5 offset:0
    ds_read_b64_tr_b16 v[170:171], v5 offset:256
    v_mfma_f32_16x16x32_bf16 v[116:119], v[172:175], v[148:151], v[116:119]
    ds_read_b64_tr_b16 v[172:173], v5 offset:4096
    ds_read_b64_tr_b16 v[174:175], v5 offset:4352
    v_mfma_f32_16x16x32_bf16 v[124:127], v[176:179], v[144:147], v[124:127]
    ds_read_b64_tr_b16 v[176:177], v6 offset:0
    ds_read_b64_tr_b16 v[178:179], v6 offset:256
    v_mfma_f32_16x16x32_bf16 v[124:127], v[180:183], v[148:151], v[124:127]
    ds_read_b64_tr_b16 v[180:181], v6 offset:4096
    ds_read_b64_tr_b16 v[182:183], v6 offset:4352
    s_waitcnt lgkmcnt(14)
    v_mfma_f32_16x16x32_bf16 v[32:35], v[152:155], v[128:131], v[32:35]
    ds_read_b128 v[144:147], v2 offset:4096
    v_mfma_f32_16x16x32_bf16 v[32:35], v[156:159], v[132:135], v[32:35]
    ds_read_b128 v[148:151], v3 offset:4096
    s_waitcnt lgkmcnt(14)
    v_mfma_f32_16x16x32_bf16 v[40:43], v[160:163], v[128:131], v[40:43]
    s_waitcnt lgkmcnt(12)
    v_mfma_f32_16x16x32_bf16 v[40:43], v[164:167], v[132:135], v[40:43]
    s_waitcnt lgkmcnt(8)
    v_mfma_f32_16x16x32_bf16 v[48:51], v[168:171], v[128:131], v[48:51]
    s_waitcnt lgkmcnt(6)
    v_mfma_f32_16x16x32_bf16 v[48:51], v[172:175], v[132:135], v[48:51]
    s_waitcnt lgkmcnt(4)
    v_mfma_f32_16x16x32_bf16 v[56:59], v[176:179], v[128:131], v[56:59]
    s_waitcnt lgkmcnt(2)
    v_mfma_f32_16x16x32_bf16 v[56:59], v[180:183], v[132:135], v[56:59]
    v_mfma_f32_16x16x32_bf16 v[36:39], v[152:155], v[136:139], v[36:39]
    ds_read_b128 v[128:131], v2 offset:6144
    v_mfma_f32_16x16x32_bf16 v[36:39], v[156:159], v[140:143], v[36:39]
    ds_read_b128 v[132:135], v3 offset:6144
    v_mfma_f32_16x16x32_bf16 v[44:47], v[160:163], v[136:139], v[44:47]
    v_mfma_f32_16x16x32_bf16 v[44:47], v[164:167], v[140:143], v[44:47]
    v_mfma_f32_16x16x32_bf16 v[52:55], v[168:171], v[136:139], v[52:55]
    v_mfma_f32_16x16x32_bf16 v[52:55], v[172:175], v[140:143], v[52:55]
    v_mfma_f32_16x16x32_bf16 v[60:63], v[176:179], v[136:139], v[60:63]
    v_mfma_f32_16x16x32_bf16 v[60:63], v[180:183], v[140:143], v[60:63]
    s_waitcnt lgkmcnt(2)
    v_mfma_f32_16x16x32_bf16 v[64:67], v[152:155], v[144:147], v[64:67]
    ds_read_b128 v[136:139], v2 offset:8192
    v_mfma_f32_16x16x32_bf16 v[64:67], v[156:159], v[148:151], v[64:67]
    ds_read_b128 v[140:143], v3 offset:8192
    v_mfma_f32_16x16x32_bf16 v[72:75], v[160:163], v[144:147], v[72:75]
    v_mfma_f32_16x16x32_bf16 v[72:75], v[164:167], v[148:151], v[72:75]
    v_cvt_pk_bf16_f32 v216, v32, v33
    v_cvt_pk_bf16_f32 v217, v34, v35
    v_mfma_f32_16x16x32_bf16 v[80:83], v[168:171], v[144:147], v[80:83]
    v_cvt_pk_bf16_f32 v218, v36, v37
    v_cvt_pk_bf16_f32 v219, v38, v39
    v_mfma_f32_16x16x32_bf16 v[80:83], v[172:175], v[148:151], v[80:83]
    v_cvt_pk_bf16_f32 v224, v48, v49
    v_cvt_pk_bf16_f32 v225, v50, v51
    v_mfma_f32_16x16x32_bf16 v[88:91], v[176:179], v[144:147], v[88:91]
    v_cvt_pk_bf16_f32 v226, v52, v53
    v_cvt_pk_bf16_f32 v227, v54, v55
    v_mfma_f32_16x16x32_bf16 v[88:91], v[180:183], v[148:151], v[88:91]
    v_permlane16_swap_b32 v216, v218
    s_waitcnt lgkmcnt(2)
    v_mfma_f32_16x16x32_bf16 v[68:71], v[152:155], v[128:131], v[68:71]
    ds_read_b128 v[144:147], v2 offset:10240
    v_mfma_f32_16x16x32_bf16 v[68:71], v[156:159], v[132:135], v[68:71]
    ds_read_b128 v[148:151], v3 offset:10240
    v_mfma_f32_16x16x32_bf16 v[76:79], v[160:163], v[128:131], v[76:79]
    v_permlane16_swap_b32 v217, v219
    v_mfma_f32_16x16x32_bf16 v[76:79], v[164:167], v[132:135], v[76:79]
    v_cvt_pk_bf16_f32 v220, v40, v41
    v_cvt_pk_bf16_f32 v221, v42, v43
    v_mfma_f32_16x16x32_bf16 v[84:87], v[168:171], v[128:131], v[84:87]
    v_cvt_pk_bf16_f32 v222, v44, v45
    v_cvt_pk_bf16_f32 v223, v46, v47
    v_mfma_f32_16x16x32_bf16 v[84:87], v[172:175], v[132:135], v[84:87]
    v_permlane16_swap_b32 v224, v226
    v_mfma_f32_16x16x32_bf16 v[92:95], v[176:179], v[128:131], v[92:95]
    v_permlane16_swap_b32 v225, v227
    v_mfma_f32_16x16x32_bf16 v[92:95], v[180:183], v[132:135], v[92:95]
    v_cvt_pk_bf16_f32 v228, v56, v57
    v_cvt_pk_bf16_f32 v229, v58, v59
    s_waitcnt lgkmcnt(0)
    s_barrier
    v_mfma_f32_16x16x32_bf16 v[96:99], v[152:155], v[136:139], v[96:99]
    v_cvt_pk_bf16_f32 v230, v60, v61
    v_cvt_pk_bf16_f32 v231, v62, v63
    v_mfma_f32_16x16x32_bf16 v[96:99], v[156:159], v[140:143], v[96:99]
    v_cndmask_b32 v226, v226, v248, s[66:67]
    v_mfma_f32_32x32x16_bf16 v[32:47], v[184:187], v[216:219], 0
    v_mfma_f32_16x16x32_bf16 v[104:107], v[160:163], v[136:139], v[104:107]
    v_mfma_f32_16x16x32_bf16 v[104:107], v[164:167], v[140:143], v[104:107]
    v_cvt_pk_bf16_f32 v232, v64, v65
    v_cvt_pk_bf16_f32 v233, v66, v67
    v_mfma_f32_16x16x32_bf16 v[112:115], v[168:171], v[136:139], v[112:115]
    v_cvt_pk_bf16_f32 v234, v68, v69
    v_cvt_pk_bf16_f32 v235, v70, v71
    v_mfma_f32_16x16x32_bf16 v[112:115], v[172:175], v[140:143], v[112:115]
    v_mfma_f32_32x32x16_bf16 v[48:63], v[192:195], v[216:219], 0
    v_cvt_pk_bf16_f32 v240, v80, v81
    v_cvt_pk_bf16_f32 v241, v82, v83
    v_cvt_pk_bf16_f32 v242, v84, v85
    v_cvt_pk_bf16_f32 v243, v86, v87
    v_mfma_f32_16x16x32_bf16 v[120:123], v[176:179], v[136:139], v[120:123]
    v_permlane16_swap_b32 v232, v234
    v_mfma_f32_16x16x32_bf16 v[120:123], v[180:183], v[140:143], v[120:123]
    v_permlane16_swap_b32 v233, v235
    v_mfma_f32_16x16x32_bf16 v[100:103], v[152:155], v[144:147], v[100:103]
    v_cvt_pk_bf16_f32 v236, v72, v73
    v_cvt_pk_bf16_f32 v237, v74, v75
    v_mfma_f32_16x16x32_bf16 v[100:103], v[156:159], v[148:151], v[100:103]
    v_mfma_f32_32x32x16_bf16 v[32:47], v[188:191], v[224:227], v[32:47]
    v_cvt_pk_bf16_f32 v238, v76, v77
    v_cvt_pk_bf16_f32 v239, v78, v79
    v_permlane16_swap_b32 v240, v242
    v_permlane16_swap_b32 v241, v243
    v_mfma_f32_16x16x32_bf16 v[108:111], v[160:163], v[144:147], v[108:111]
    v_cvt_pk_bf16_f32 v244, v88, v89
    v_cvt_pk_bf16_f32 v245, v90, v91
    v_mfma_f32_16x16x32_bf16 v[108:111], v[164:167], v[148:151], v[108:111]
    v_cvt_pk_bf16_f32 v246, v92, v93
    v_cvt_pk_bf16_f32 v247, v94, v95
    v_mfma_f32_16x16x32_bf16 v[116:119], v[168:171], v[144:147], v[116:119]
    v_cndmask_b32 v242, v242, v249, s[66:67]
    v_mfma_f32_16x16x32_bf16 v[116:119], v[172:175], v[148:151], v[116:119]
    v_mfma_f32_32x32x16_bf16 v[48:63], v[196:199], v[224:227], v[48:63]
    v_mfma_f32_16x16x32_bf16 v[124:127], v[176:179], v[144:147], v[124:127]
    v_mfma_f32_16x16x32_bf16 v[124:127], v[180:183], v[148:151], v[124:127]
    v_mfma_f32_32x32x16_bf16 v[64:79], v[184:187], v[232:235], 0
    v_mfma_f32_32x32x16_bf16 v[80:95], v[192:195], v[232:235], 0
    v_cvt_pk_bf16_f32 v168, v96, v97
    v_cvt_pk_bf16_f32 v169, v98, v99
    v_cvt_pk_bf16_f32 v170, v100, v101
    v_cvt_pk_bf16_f32 v171, v102, v103
    v_cvt_pk_bf16_f32 v176, v112, v113
    v_cvt_pk_bf16_f32 v177, v114, v115
    v_cvt_pk_bf16_f32 v178, v116, v117
    v_mfma_f32_32x32x16_bf16 v[64:79], v[188:191], v[240:243], v[64:79]
    v_cvt_pk_bf16_f32 v179, v118, v119
    v_permlane16_swap_b32 v168, v170
    v_permlane16_swap_b32 v169, v171
    v_cvt_pk_bf16_f32 v172, v104, v105
    v_cvt_pk_bf16_f32 v173, v106, v107
    v_cvt_pk_bf16_f32 v174, v108, v109
    v_cvt_pk_bf16_f32 v175, v110, v111
    v_mfma_f32_32x32x16_bf16 v[80:95], v[196:199], v[240:243], v[80:95]
    v_permlane16_swap_b32 v176, v178
    v_permlane16_swap_b32 v177, v179
    v_cvt_pk_bf16_f32 v180, v120, v121
    v_cvt_pk_bf16_f32 v181, v122, v123
    v_cvt_pk_bf16_f32 v182, v124, v125
    v_cvt_pk_bf16_f32 v183, v126, v127
    v_cndmask_b32 v178, v178, v250, s[66:67]
    v_mfma_f32_32x32x16_bf16 v[96:111], v[184:187], v[168:171], 0
    v_max3_f32 v52, v32, v33, v34
    v_max3_f32 v53, v35, v36, v37
    v_max3_f32 v52, v52, v38, v39
    v_max3_f32 v53, v53, v40, v41
    v_max3_f32 v52, v52, v42, v43
    v_mfma_f32_32x32x16_bf16 v[112:127], v[192:195], v[168:171], 0
    v_max3_f32 v53, v53, v44, v45
    v_max3_f32 v52, v52, v46, v47
    v_max3_f32 v53, v53, v48, v49
    v_max3_f32 v52, v52, v50, v51
    v_max_f32_e64 v52, v52, v53
    v_mfma_f32_32x32x16_bf16 v[96:111], v[188:191], v[176:179], v[96:111]
    v_mul_f32_e64 v52, s64, v52
    v_pk_fma_f32 v[32:33], v[32:33], s[64:65], v[52:53] op_sel_hi:[1,0,0] neg_lo:[0,0,1] neg_hi:[0,0,1]
    v_pk_fma_f32 v[34:35], v[34:35], s[64:65], v[52:53] op_sel_hi:[1,0,0] neg_lo:[0,0,1] neg_hi:[0,0,1]
    v_exp_f32 v32, v32
    v_exp_f32 v33, v33
    v_mfma_f32_32x32x16_bf16 v[112:127], v[196:199], v[176:179], v[112:127]
    v_pk_fma_f32 v[36:37], v[36:37], s[64:65], v[52:53] op_sel_hi:[1,0,0] neg_lo:[0,0,1] neg_hi:[0,0,1]
    v_exp_f32 v34, v34
    v_exp_f32 v35, v35
    v_pk_fma_f32 v[38:39], v[38:39], s[64:65], v[52:53] op_sel_hi:[1,0,0] neg_lo:[0,0,1] neg_hi:[0,0,1]
    v_exp_f32 v36, v36
    v_exp_f32 v37, v37
    v_pk_fma_f32 v[40:41], v[40:41], s[64:65], v[52:53] op_sel_hi:[1,0,0] neg_lo:[0,0,1] neg_hi:[0,0,1]
    v_pk_add_f32 v[54:55], v[32:33], v[34:35]
    v_exp_f32 v38, v38
    v_exp_f32 v39, v39
    v_pk_fma_f32 v[42:43], v[42:43], s[64:65], v[52:53] op_sel_hi:[1,0,0] neg_lo:[0,0,1] neg_hi:[0,0,1]
    v_pk_add_f32 v[54:55], v[54:55], v[36:37]
    v_exp_f32 v40, v40
    v_exp_f32 v41, v41
    v_pk_fma_f32 v[44:45], v[44:45], s[64:65], v[52:53] op_sel_hi:[1,0,0] neg_lo:[0,0,1] neg_hi:[0,0,1]
    v_pk_add_f32 v[54:55], v[54:55], v[38:39]
    v_exp_f32 v42, v42
    v_exp_f32 v43, v43
    v_pk_fma_f32 v[46:47], v[46:47], s[64:65], v[52:53] op_sel_hi:[1,0,0] neg_lo:[0,0,1] neg_hi:[0,0,1]
    v_pk_add_f32 v[54:55], v[54:55], v[40:41]
    v_exp_f32 v44, v44
    v_exp_f32 v45, v45
    v_pk_fma_f32 v[48:49], v[48:49], s[64:65], v[52:53] op_sel_hi:[1,0,0] neg_lo:[0,0,1] neg_hi:[0,0,1]
    v_pk_add_f32 v[54:55], v[54:55], v[42:43]
    v_exp_f32 v46, v46
    v_exp_f32 v47, v47
    v_pk_fma_f32 v[50:51], v[50:51], s[64:65], v[52:53] op_sel_hi:[1,0,0] neg_lo:[0,0,1] neg_hi:[0,0,1]
    v_pk_add_f32 v[54:55], v[54:55], v[44:45]
    v_exp_f32 v48, v48
    v_exp_f32 v49, v49
    v_pk_add_f32 v[54:55], v[54:55], v[46:47]
    v_exp_f32 v50, v50
    v_exp_f32 v51, v51
    v_pk_add_f32 v[54:55], v[54:55], v[48:49]
    ds_write_b64 v13, v[220:221] offset:0
    ds_write_b64 v13, v[222:223] offset:2048
    v_pk_add_f32 v[54:55], v[54:55], v[50:51]
    v_add_f32 v54, v54, v55
    v_rcp_f32 v54, v54
    ds_write_b64 v15, v[226:227] offset:0
    v_pk_mul_f32 v[32:33], v[32:33], v[54:55] op_sel_hi:[1,0]
    v_pk_mul_f32 v[34:35], v[34:35], v[54:55] op_sel_hi:[1,0]
    v_pk_mul_f32 v[36:37], v[36:37], v[54:55] op_sel_hi:[1,0]
    v_cvt_pk_bf16_f32 v128, v32, v33
    v_pk_mul_f32 v[38:39], v[38:39], v[54:55] op_sel_hi:[1,0]
    v_cvt_pk_bf16_f32 v129, v34, v35
    v_pk_mul_f32 v[40:41], v[40:41], v[54:55] op_sel_hi:[1,0]
    v_cvt_pk_bf16_f32 v130, v36, v37
    v_pk_mul_f32 v[42:43], v[42:43], v[54:55] op_sel_hi:[1,0]
    v_cvt_pk_bf16_f32 v131, v38, v39
    v_pk_mul_f32 v[44:45], v[44:45], v[54:55] op_sel_hi:[1,0]
    v_cvt_pk_bf16_f32 v132, v40, v41
    v_pk_mul_f32 v[46:47], v[46:47], v[54:55] op_sel_hi:[1,0]
    v_cvt_pk_bf16_f32 v133, v42, v43
    v_pk_mul_f32 v[48:49], v[48:49], v[54:55] op_sel_hi:[1,0]
    v_cvt_pk_bf16_f32 v134, v44, v45
    v_pk_mul_f32 v[50:51], v[50:51], v[54:55] op_sel_hi:[1,0]
    v_cvt_pk_bf16_f32 v135, v46, v47
    v_cvt_pk_bf16_f32 v136, v48, v49
    v_cvt_pk_bf16_f32 v137, v50, v51
    v_max3_f32 v84, v64, v65, v66
    v_max3_f32 v85, v67, v68, v69
    v_max3_f32 v84, v84, v70, v71
    v_max3_f32 v85, v85, v72, v73
    v_max3_f32 v84, v84, v74, v75
    v_max3_f32 v85, v85, v76, v77
    v_max3_f32 v84, v84, v78, v79
    v_max3_f32 v85, v85, v80, v81
    v_max3_f32 v84, v84, v82, v83
    v_max_f32 v84, v84, v85
    v_mul_f32 v84, s64, v84
    v_pk_fma_f32 v[64:65], v[64:65], s[64:65], v[84:85] op_sel_hi:[1,0,0] neg_lo:[0,0,1] neg_hi:[0,0,1]
    v_pk_fma_f32 v[66:67], v[66:67], s[64:65], v[84:85] op_sel_hi:[1,0,0] neg_lo:[0,0,1] neg_hi:[0,0,1]
    ds_write_b64 v8, v[128:129] offset:0
    ds_write_b64 v9, v[130:131] offset:0
    v_exp_f32 v64, v64
    v_exp_f32 v65, v65
    v_pk_fma_f32 v[68:69], v[68:69], s[64:65], v[84:85] op_sel_hi:[1,0,0] neg_lo:[0,0,1] neg_hi:[0,0,1]
    v_exp_f32 v66, v66
    v_exp_f32 v67, v67
    v_pk_fma_f32 v[70:71], v[70:71], s[64:65], v[84:85] op_sel_hi:[1,0,0] neg_lo:[0,0,1] neg_hi:[0,0,1]
    v_exp_f32 v68, v68
    v_exp_f32 v69, v69
    v_pk_fma_f32 v[72:73], v[72:73], s[64:65], v[84:85] op_sel_hi:[1,0,0] neg_lo:[0,0,1] neg_hi:[0,0,1]
    v_pk_add_f32 v[86:87], v[64:65], v[66:67]
    v_exp_f32 v70, v70
    v_exp_f32 v71, v71
    v_pk_fma_f32 v[74:75], v[74:75], s[64:65], v[84:85] op_sel_hi:[1,0,0] neg_lo:[0,0,1] neg_hi:[0,0,1]
    ds_write_b64 v10, v[132:133] offset:0
    ds_write_b64 v11, v[134:135] offset:0
    v_pk_add_f32 v[86:87], v[86:87], v[68:69]
    v_exp_f32 v72, v72
    v_exp_f32 v73, v73
    v_pk_fma_f32 v[76:77], v[76:77], s[64:65], v[84:85] op_sel_hi:[1,0,0] neg_lo:[0,0,1] neg_hi:[0,0,1]
    v_pk_add_f32 v[86:87], v[86:87], v[70:71]
    v_exp_f32 v74, v74
    v_exp_f32 v75, v75
    v_pk_fma_f32 v[78:79], v[78:79], s[64:65], v[84:85] op_sel_hi:[1,0,0] neg_lo:[0,0,1] neg_hi:[0,0,1]
    v_pk_add_f32 v[86:87], v[86:87], v[72:73]
    v_exp_f32 v76, v76
    v_exp_f32 v77, v77
    v_pk_fma_f32 v[80:81], v[80:81], s[64:65], v[84:85] op_sel_hi:[1,0,0] neg_lo:[0,0,1] neg_hi:[0,0,1]
    v_pk_add_f32 v[86:87], v[86:87], v[74:75]
    ds_write_b64 v12, v[136:137] offset:0
    ds_write_b64 v13, v[236:237] offset:4096
    v_exp_f32 v78, v78
    v_exp_f32 v79, v79
    v_pk_fma_f32 v[82:83], v[82:83], s[64:65], v[84:85] op_sel_hi:[1,0,0] neg_lo:[0,0,1] neg_hi:[0,0,1]
    v_pk_add_f32 v[86:87], v[86:87], v[76:77]
    v_exp_f32 v80, v80
    v_exp_f32 v81, v81
    v_pk_add_f32 v[86:87], v[86:87], v[78:79]
    v_exp_f32 v82, v82
    v_exp_f32 v83, v83
    v_pk_add_f32 v[86:87], v[86:87], v[80:81]
    v_pk_add_f32 v[86:87], v[86:87], v[82:83]
    v_add_f32 v86, v86, v87
    v_rcp_f32 v86, v86
    ds_write_b64 v13, v[238:239] offset:6144
    ds_write_b64 v15, v[242:243] offset:4096
    v_pk_mul_f32 v[64:65], v[64:65], v[86:87] op_sel_hi:[1,0]
    v_pk_mul_f32 v[66:67], v[66:67], v[86:87] op_sel_hi:[1,0]
    v_pk_mul_f32 v[68:69], v[68:69], v[86:87] op_sel_hi:[1,0]
    v_cvt_pk_bf16_f32 v140, v64, v65
    v_pk_mul_f32 v[70:71], v[70:71], v[86:87] op_sel_hi:[1,0]
    v_cvt_pk_bf16_f32 v141, v66, v67
    v_pk_mul_f32 v[72:73], v[72:73], v[86:87] op_sel_hi:[1,0]
    v_cvt_pk_bf16_f32 v142, v68, v69
    v_pk_mul_f32 v[74:75], v[74:75], v[86:87] op_sel_hi:[1,0]
    v_cvt_pk_bf16_f32 v143, v70, v71
    v_pk_mul_f32 v[76:77], v[76:77], v[86:87] op_sel_hi:[1,0]
    v_cvt_pk_bf16_f32 v144, v72, v73
    v_pk_mul_f32 v[78:79], v[78:79], v[86:87] op_sel_hi:[1,0]
    v_cvt_pk_bf16_f32 v145, v74, v75
    v_pk_mul_f32 v[80:81], v[80:81], v[86:87] op_sel_hi:[1,0]
    v_cvt_pk_bf16_f32 v146, v76, v77
    v_pk_mul_f32 v[82:83], v[82:83], v[86:87] op_sel_hi:[1,0]
    v_cvt_pk_bf16_f32 v147, v78, v79
    v_cvt_pk_bf16_f32 v148, v80, v81
    v_cvt_pk_bf16_f32 v149, v82, v83
    v_max3_f32 v116, v96, v97, v98
    v_max3_f32 v117, v99, v100, v101
    v_max3_f32 v116, v116, v102, v103
    v_max3_f32 v117, v117, v104, v105
    v_max3_f32 v116, v116, v106, v107
    v_max3_f32 v117, v117, v108, v109
    v_max3_f32 v116, v116, v110, v111
    v_max3_f32 v117, v117, v112, v113
    v_max3_f32 v116, v116, v114, v115
    v_max_f32 v116, v116, v117
    v_mul_f32 v116, s64, v116
    v_pk_fma_f32 v[96:97], v[96:97], s[64:65], v[116:117] op_sel_hi:[1,0,0] neg_lo:[0,0,1] neg_hi:[0,0,1]
    v_pk_fma_f32 v[98:99], v[98:99], s[64:65], v[116:117] op_sel_hi:[1,0,0] neg_lo:[0,0,1] neg_hi:[0,0,1]
    ds_write_b64 v8, v[140:141] offset:4096
    ds_write_b64 v9, v[142:143] offset:4096
    v_exp_f32 v96, v96
    v_exp_f32 v97, v97
    v_pk_fma_f32 v[100:101], v[100:101], s[64:65], v[116:117] op_sel_hi:[1,0,0] neg_lo:[0,0,1] neg_hi:[0,0,1]
    v_exp_f32 v98, v98
    v_exp_f32 v99, v99
    v_pk_fma_f32 v[102:103], v[102:103], s[64:65], v[116:117] op_sel_hi:[1,0,0] neg_lo:[0,0,1] neg_hi:[0,0,1]
    v_exp_f32 v100, v100
    v_exp_f32 v101, v101
    v_pk_fma_f32 v[104:105], v[104:105], s[64:65], v[116:117] op_sel_hi:[1,0,0] neg_lo:[0,0,1] neg_hi:[0,0,1]
    v_pk_add_f32 v[118:119], v[96:97], v[98:99]
    v_exp_f32 v102, v102
    v_exp_f32 v103, v103
    v_pk_fma_f32 v[106:107], v[106:107], s[64:65], v[116:117] op_sel_hi:[1,0,0] neg_lo:[0,0,1] neg_hi:[0,0,1]
    ds_write_b64 v10, v[144:145] offset:4096
    ds_write_b64 v11, v[146:147] offset:4096
    v_pk_add_f32 v[118:119], v[118:119], v[100:101]
    v_exp_f32 v104, v104
    v_exp_f32 v105, v105
    v_pk_fma_f32 v[108:109], v[108:109], s[64:65], v[116:117] op_sel_hi:[1,0,0] neg_lo:[0,0,1] neg_hi:[0,0,1]
    v_pk_add_f32 v[118:119], v[118:119], v[102:103]
    v_exp_f32 v106, v106
    v_exp_f32 v107, v107
    v_pk_fma_f32 v[110:111], v[110:111], s[64:65], v[116:117] op_sel_hi:[1,0,0] neg_lo:[0,0,1] neg_hi:[0,0,1]
    v_pk_add_f32 v[118:119], v[118:119], v[104:105]
    v_exp_f32 v108, v108
    v_exp_f32 v109, v109
    v_pk_fma_f32 v[112:113], v[112:113], s[64:65], v[116:117] op_sel_hi:[1,0,0] neg_lo:[0,0,1] neg_hi:[0,0,1]
    v_pk_add_f32 v[118:119], v[118:119], v[106:107]
    ds_write_b64 v12, v[148:149] offset:4096
    ds_write_b64 v13, v[172:173] offset:8192
    v_exp_f32 v110, v110
    v_exp_f32 v111, v111
    v_pk_fma_f32 v[114:115], v[114:115], s[64:65], v[116:117] op_sel_hi:[1,0,0] neg_lo:[0,0,1] neg_hi:[0,0,1]
    v_pk_add_f32 v[118:119], v[118:119], v[108:109]
    v_exp_f32 v112, v112
    v_exp_f32 v113, v113
    v_pk_add_f32 v[118:119], v[118:119], v[110:111]
    v_exp_f32 v114, v114
    v_exp_f32 v115, v115
    v_pk_add_f32 v[118:119], v[118:119], v[112:113]
    v_pk_add_f32 v[118:119], v[118:119], v[114:115]
    v_add_f32 v118, v118, v119
    v_rcp_f32 v118, v118
    ds_write_b64 v13, v[174:175] offset:10240
    ds_write_b64 v15, v[178:179] offset:8192
    v_pk_mul_f32 v[96:97], v[96:97], v[118:119] op_sel_hi:[1,0]
    v_pk_mul_f32 v[98:99], v[98:99], v[118:119] op_sel_hi:[1,0]
    v_pk_mul_f32 v[100:101], v[100:101], v[118:119] op_sel_hi:[1,0]
    v_cvt_pk_bf16_f32 v152, v96, v97
    v_pk_mul_f32 v[102:103], v[102:103], v[118:119] op_sel_hi:[1,0]
    v_cvt_pk_bf16_f32 v153, v98, v99
    ds_write_b64 v8, v[152:153] offset:8192
    v_pk_mul_f32 v[104:105], v[104:105], v[118:119] op_sel_hi:[1,0]
    v_cvt_pk_bf16_f32 v154, v100, v101
    v_pk_mul_f32 v[106:107], v[106:107], v[118:119] op_sel_hi:[1,0]
    v_cvt_pk_bf16_f32 v155, v102, v103
    ds_write_b64 v9, v[154:155] offset:8192
    v_pk_mul_f32 v[108:109], v[108:109], v[118:119] op_sel_hi:[1,0]
    v_cvt_pk_bf16_f32 v156, v104, v105
    v_pk_mul_f32 v[110:111], v[110:111], v[118:119] op_sel_hi:[1,0]
    v_cvt_pk_bf16_f32 v157, v106, v107
    ds_write_b64 v10, v[156:157] offset:8192
    v_pk_mul_f32 v[112:113], v[112:113], v[118:119] op_sel_hi:[1,0]
    v_cvt_pk_bf16_f32 v158, v108, v109
    v_pk_mul_f32 v[114:115], v[114:115], v[118:119] op_sel_hi:[1,0]
    v_cvt_pk_bf16_f32 v159, v110, v111
    ds_write_b64 v11, v[158:159] offset:8192
    v_cvt_pk_bf16_f32 v160, v112, v113
    v_cvt_pk_bf16_f32 v161, v114, v115
    ds_write_b64 v12, v[160:161] offset:8192
    s_waitcnt lgkmcnt(0)
    s_barrier
L_c_tail:
    ds_read_b64_tr_b16 v[44:45], v22 offset:0
    ds_read_b64_tr_b16 v[46:47], v23 offset:512
    ds_read_b64_tr_b16 v[32:33], v16 offset:0
    ds_read_b64_tr_b16 v[34:35], v17 offset:512
    v_permlane16_swap_b32 v228, v230
    v_permlane16_swap_b32 v229, v231
    ds_read_b64_tr_b16 v[36:37], v18 offset:0
    ds_read_b64_tr_b16 v[38:39], v19 offset:512
    v_mfma_f32_32x32x16_bf16 v[128:143], v[200:203], v[228:231], 0
    ds_read_b64_tr_b16 v[40:41], v20 offset:0
    ds_read_b64_tr_b16 v[42:43], v21 offset:512
    ds_read_b32 v29, v31 offset:49152
    ds_read_b64_tr_b16 v[60:61], v22 offset:4096
    v_mfma_f32_32x32x16_bf16 v[144:159], v[208:211], v[228:231], 0
    ds_read_b64_tr_b16 v[62:63], v23 offset:4608
    ds_read_b64_tr_b16 v[48:49], v16 offset:4096
    ds_read_b64_tr_b16 v[50:51], v17 offset:4608
    ds_read_b64_tr_b16 v[52:53], v18 offset:4096
    s_waitcnt lgkmcnt(10)
    v_mfma_f32_16x16x32_bf16 v[216:219], v[32:35], v[44:47], 0
    ds_read_b64_tr_b16 v[54:55], v19 offset:4608
    ds_read_b64_tr_b16 v[56:57], v20 offset:4096
    ds_read_b64_tr_b16 v[58:59], v21 offset:4608
    s_waitcnt lgkmcnt(11)
    v_mfma_f32_16x16x32_bf16 v[232:235], v[36:39], v[44:47], 0
    ds_read_b64_tr_b16 v[76:77], v22 offset:8192
    ds_read_b64_tr_b16 v[78:79], v23 offset:8704
    ds_read_b64_tr_b16 v[64:65], v16 offset:8192
    s_waitcnt lgkmcnt(12)
    v_mfma_f32_16x16x32_bf16 v[168:171], v[40:43], v[44:47], 0
    v_mfma_f32_32x32x16_bf16 v[128:143], v[204:207], v[224:227], v[128:143]
    ds_read_b64_tr_b16 v[66:67], v17 offset:8704
    ds_read_b64_tr_b16 v[68:69], v18 offset:8192
    ds_read_b64_tr_b16 v[70:71], v19 offset:8704
    s_waitcnt lgkmcnt(10)
    v_mfma_f32_16x16x32_bf16 v[216:219], v[48:51], v[60:63], v[216:219]
    ds_read_b64_tr_b16 v[72:73], v20 offset:8192
    ds_read_b64_tr_b16 v[74:75], v21 offset:8704
    ds_read_b64_tr_b16 v[92:93], v22 offset:12288
    s_waitcnt lgkmcnt(11)
    v_mfma_f32_16x16x32_bf16 v[232:235], v[52:55], v[60:63], v[232:235]
    ds_read_b64_tr_b16 v[94:95], v23 offset:12800
    ds_read_b64_tr_b16 v[80:81], v16 offset:12288
    ds_read_b64_tr_b16 v[82:83], v17 offset:12800
    s_waitcnt lgkmcnt(12)
    v_mfma_f32_16x16x32_bf16 v[168:171], v[56:59], v[60:63], v[168:171]
    v_mfma_f32_32x32x16_bf16 v[144:159], v[212:215], v[224:227], v[144:159]
    ds_read_b64_tr_b16 v[84:85], v18 offset:12288
    ds_read_b64_tr_b16 v[86:87], v19 offset:12800
    ds_read_b64_tr_b16 v[88:89], v20 offset:12288
    s_waitcnt lgkmcnt(11)
    v_mfma_f32_16x16x32_bf16 v[216:219], v[64:67], v[76:79], v[216:219]
    ds_read_b64_tr_b16 v[90:91], v21 offset:12800
    ds_read_b64_tr_b16 v[108:109], v22 offset:16384
    ds_read_b64_tr_b16 v[110:111], v23 offset:16896
    s_waitcnt lgkmcnt(12)
    v_mfma_f32_16x16x32_bf16 v[232:235], v[68:71], v[76:79], v[232:235]
    ds_read_b64_tr_b16 v[96:97], v16 offset:16384
    ds_read_b64_tr_b16 v[98:99], v17 offset:16896
    ds_read_b64_tr_b16 v[100:101], v18 offset:16384
    s_waitcnt lgkmcnt(13)
    v_mfma_f32_16x16x32_bf16 v[168:171], v[72:75], v[76:79], v[168:171]
    ds_read_b64_tr_b16 v[102:103], v19 offset:16896
    ds_read_b64_tr_b16 v[104:105], v20 offset:16384
    ds_read_b64_tr_b16 v[106:107], v21 offset:16896
    s_waitcnt lgkmcnt(12)
    v_mfma_f32_16x16x32_bf16 v[216:219], v[80:83], v[92:95], v[216:219]
    ds_read_b64_tr_b16 v[124:125], v22 offset:20480
    ds_read_b64_tr_b16 v[126:127], v23 offset:20992
    ds_read_b64_tr_b16 v[112:113], v16 offset:20480
    s_waitcnt lgkmcnt(13)
    v_mfma_f32_16x16x32_bf16 v[232:235], v[84:87], v[92:95], v[232:235]
    ds_read_b64_tr_b16 v[114:115], v17 offset:20992
    ds_read_b64_tr_b16 v[116:117], v18 offset:20480
    ds_read_b64_tr_b16 v[118:119], v19 offset:20992
    s_waitcnt lgkmcnt(14)
    v_mfma_f32_16x16x32_bf16 v[168:171], v[88:91], v[92:95], v[168:171]
    ds_read_b64_tr_b16 v[120:121], v20 offset:20480
    ds_read_b64_tr_b16 v[122:123], v21 offset:20992
    v_readfirstlane_b32 s39, v29
    s_waitcnt lgkmcnt(12)
    v_mfma_f32_16x16x32_bf16 v[216:219], v[96:99], v[108:111], v[216:219]
    s_nop 0
    s_and_b32 s39, s39, 8192
    s_add_u32 s52, s52, s39
    s_waitcnt lgkmcnt(10)
    v_mfma_f32_16x16x32_bf16 v[232:235], v[100:103], v[108:111], v[232:235]
    s_addc_u32 s53, s53, 0
    s_add_u32 s56, s56, s39
    s_addc_u32 s57, s57, 0
    s_waitcnt lgkmcnt(8)
    v_mfma_f32_16x16x32_bf16 v[168:171], v[104:107], v[108:111], v[168:171]
    s_waitcnt lgkmcnt(4)
    v_mfma_f32_16x16x32_bf16 v[216:219], v[112:115], v[124:127], v[216:219]
    s_waitcnt lgkmcnt(2)
    v_mfma_f32_16x16x32_bf16 v[232:235], v[116:119], v[124:127], v[232:235]
    s_waitcnt lgkmcnt(0)
    v_mfma_f32_16x16x32_bf16 v[168:171], v[120:123], v[124:127], v[168:171]
    v_permlane16_swap_b32 v244, v246
    v_permlane16_swap_b32 v245, v247
    v_permlane16_swap_b32 v180, v182
    v_permlane16_swap_b32 v181, v183
    v_cvt_pk_bf16_f32 v220, v216, v217
    v_cvt_pk_bf16_f32 v221, v218, v219
    v_cvt_pk_bf16_f32 v222, v232, v233
    v_cvt_pk_bf16_f32 v223, v234, v235
    v_cvt_pk_bf16_f32 v236, v168, v169
    v_cvt_pk_bf16_f32 v237, v170, v171
    buffer_store_dwordx4 v[220:223], v251, s[56:59], 0 offen sc1
    v_permlane16_swap_b32 v236, v238
    v_permlane16_swap_b32 v237, v239
    buffer_store_dwordx4 v[236:239], v252, s[56:59], 0 offen sc1
    s_setprio 0
    s_barrier
    v_mfma_f32_32x32x16_bf16 v[64:79], v[200:203], v[244:247], 0
    v_max3_f32 v148, v128, v129, v130
    v_max3_f32 v149, v131, v132, v133
    v_max3_f32 v148, v148, v134, v135
    v_max3_f32 v149, v149, v136, v137
    v_max3_f32 v148, v148, v138, v139
    v_mfma_f32_32x32x16_bf16 v[80:95], v[208:211], v[244:247], 0
    v_max3_f32 v149, v149, v140, v141
    v_max3_f32 v148, v148, v142, v143
    v_max3_f32 v149, v149, v144, v145
    v_max3_f32 v148, v148, v146, v147
    v_max_f32_e64 v148, v148, v149
    v_mfma_f32_32x32x16_bf16 v[64:79], v[204:207], v[240:243], v[64:79]
    v_mul_f32_e64 v148, s64, v148
    v_pk_fma_f32 v[128:129], v[128:129], s[64:65], v[148:149] op_sel_hi:[1,0,0] neg_lo:[0,0,1] neg_hi:[0,0,1]
    v_pk_fma_f32 v[130:131], v[130:131], s[64:65], v[148:149] op_sel_hi:[1,0,0] neg_lo:[0,0,1] neg_hi:[0,0,1]
    v_exp_f32 v128, v128
    v_exp_f32 v129, v129
    v_mfma_f32_32x32x16_bf16 v[80:95], v[212:215], v[240:243], v[80:95]
    v_pk_fma_f32 v[132:133], v[132:133], s[64:65], v[148:149] op_sel_hi:[1,0,0] neg_lo:[0,0,1] neg_hi:[0,0,1]
    v_exp_f32 v130, v130
    v_exp_f32 v131, v131
    v_pk_fma_f32 v[134:135], v[134:135], s[64:65], v[148:149] op_sel_hi:[1,0,0] neg_lo:[0,0,1] neg_hi:[0,0,1]
    v_exp_f32_e64 v132, v132
    v_mfma_f32_32x32x16_bf16 v[96:111], v[200:203], v[180:183], 0
    v_exp_f32_e64 v133, v133
    v_pk_fma_f32 v[136:137], v[136:137], s[64:65], v[148:149] op_sel_hi:[1,0,0] neg_lo:[0,0,1] neg_hi:[0,0,1]
    v_pk_add_f32 v[150:151], v[128:129], v[130:131]
    v_exp_f32 v134, v134
    v_exp_f32 v135, v135
    v_mfma_f32_32x32x16_bf16 v[112:127], v[208:211], v[180:183], 0
    v_pk_fma_f32 v[138:139], v[138:139], s[64:65], v[148:149] op_sel_hi:[1,0,0] neg_lo:[0,0,1] neg_hi:[0,0,1]
    v_pk_add_f32 v[150:151], v[150:151], v[132:133]
    v_exp_f32 v136, v136
    v_exp_f32 v137, v137
    v_pk_fma_f32 v[140:141], v[140:141], s[64:65], v[148:149] op_sel_hi:[1,0,0] neg_lo:[0,0,1] neg_hi:[0,0,1]
    v_mfma_f32_32x32x16_bf16 v[96:111], v[204:207], v[176:179], v[96:111]
    v_pk_add_f32 v[150:151], v[150:151], v[134:135]
    v_exp_f32 v138, v138
    v_exp_f32 v139, v139
    v_pk_fma_f32 v[142:143], v[142:143], s[64:65], v[148:149] op_sel_hi:[1,0,0] neg_lo:[0,0,1] neg_hi:[0,0,1]
    v_pk_add_f32 v[150:151], v[150:151], v[136:137]
    v_mfma_f32_32x32x16_bf16 v[112:127], v[212:215], v[176:179], v[112:127]
    v_exp_f32 v140, v140
    v_exp_f32 v141, v141
    v_pk_fma_f32 v[144:145], v[144:145], s[64:65], v[148:149] op_sel_hi:[1,0,0] neg_lo:[0,0,1] neg_hi:[0,0,1]
    v_pk_add_f32 v[150:151], v[150:151], v[138:139]
    v_exp_f32 v142, v142
    v_exp_f32 v143, v143
    v_pk_fma_f32 v[146:147], v[146:147], s[64:65], v[148:149] op_sel_hi:[1,0,0] neg_lo:[0,0,1] neg_hi:[0,0,1]
    v_pk_add_f32 v[150:151], v[150:151], v[140:141]
    v_exp_f32 v144, v144
    v_exp_f32 v145, v145
    v_pk_add_f32 v[150:151], v[150:151], v[142:143]
    v_exp_f32 v146, v146
    v_exp_f32 v147, v147
    v_pk_add_f32 v[150:151], v[150:151], v[144:145]
    v_pk_add_f32 v[150:151], v[150:151], v[146:147]
    v_add_f32_e64 v150, v150, v151
    v_rcp_f32 v150, v150
    s_nop 0
    v_pk_mul_f32 v[128:129], v[128:129], v[150:151] op_sel_hi:[1,0]
    v_pk_mul_f32 v[130:131], v[130:131], v[150:151] op_sel_hi:[1,0]
    v_pk_mul_f32 v[132:133], v[132:133], v[150:151] op_sel_hi:[1,0]
    v_cvt_pk_bf16_f32 v128, v128, v129
    v_pk_mul_f32 v[134:135], v[134:135], v[150:151] op_sel_hi:[1,0]
    v_cvt_pk_bf16_f32 v129, v130, v131
    v_pk_mul_f32 v[136:137], v[136:137], v[150:151] op_sel_hi:[1,0]
    v_cvt_pk_bf16_f32 v130, v132, v133
    v_pk_mul_f32 v[138:139], v[138:139], v[150:151] op_sel_hi:[1,0]
    v_cvt_pk_bf16_f32 v131, v134, v135
    v_pk_mul_f32 v[140:141], v[140:141], v[150:151] op_sel_hi:[1,0]
    v_cvt_pk_bf16_f32 v132, v136, v137
    v_pk_mul_f32 v[142:143], v[142:143], v[150:151] op_sel_hi:[1,0]
    v_cvt_pk_bf16_f32 v133, v138, v139
    v_pk_mul_f32 v[144:145], v[144:145], v[150:151] op_sel_hi:[1,0]
    v_cvt_pk_bf16_f32 v134, v140, v141
    v_pk_mul_f32 v[146:147], v[146:147], v[150:151] op_sel_hi:[1,0]
    v_cvt_pk_bf16_f32 v135, v142, v143
    v_cvt_pk_bf16_f32 v136, v144, v145
    v_cvt_pk_bf16_f32 v137, v146, v147
    v_mov_b32 v138, 0
    v_mov_b32 v139, 0
    v_max3_f32 v84, v64, v65, v66
    v_max3_f32 v85, v67, v68, v69
    v_max3_f32 v84, v84, v70, v71
    v_max3_f32 v85, v85, v72, v73
    v_max3_f32 v84, v84, v74, v75
    v_max3_f32 v85, v85, v76, v77
    v_max3_f32 v84, v84, v78, v79
    v_max3_f32 v85, v85, v80, v81
    v_max3_f32 v84, v84, v82, v83
    v_max_f32 v84, v84, v85
    v_mul_f32 v84, s64, v84
    v_pk_fma_f32 v[64:65], v[64:65], s[64:65], v[84:85] op_sel_hi:[1,0,0] neg_lo:[0,0,1] neg_hi:[0,0,1]
    v_pk_fma_f32 v[66:67], v[66:67], s[64:65], v[84:85] op_sel_hi:[1,0,0] neg_lo:[0,0,1] neg_hi:[0,0,1]
    v_exp_f32 v64, v64
    v_exp_f32 v65, v65
    v_pk_fma_f32 v[68:69], v[68:69], s[64:65], v[84:85] op_sel_hi:[1,0,0] neg_lo:[0,0,1] neg_hi:[0,0,1]
    v_exp_f32 v66, v66
    v_exp_f32 v67, v67
    v_pk_fma_f32 v[70:71], v[70:71], s[64:65], v[84:85] op_sel_hi:[1,0,0] neg_lo:[0,0,1] neg_hi:[0,0,1]
    v_exp_f32 v68, v68
    v_exp_f32 v69, v69
    v_pk_fma_f32 v[72:73], v[72:73], s[64:65], v[84:85] op_sel_hi:[1,0,0] neg_lo:[0,0,1] neg_hi:[0,0,1]
    v_pk_add_f32 v[86:87], v[64:65], v[66:67]
    v_exp_f32 v70, v70
    v_exp_f32 v71, v71
    v_pk_fma_f32 v[74:75], v[74:75], s[64:65], v[84:85] op_sel_hi:[1,0,0] neg_lo:[0,0,1] neg_hi:[0,0,1]
    v_pk_add_f32 v[86:87], v[86:87], v[68:69]
    v_exp_f32 v72, v72
    v_exp_f32 v73, v73
    v_pk_fma_f32 v[76:77], v[76:77], s[64:65], v[84:85] op_sel_hi:[1,0,0] neg_lo:[0,0,1] neg_hi:[0,0,1]
    v_pk_add_f32 v[86:87], v[86:87], v[70:71]
    v_exp_f32 v74, v74
    v_exp_f32 v75, v75
    v_pk_fma_f32 v[78:79], v[78:79], s[64:65], v[84:85] op_sel_hi:[1,0,0] neg_lo:[0,0,1] neg_hi:[0,0,1]
    v_pk_add_f32 v[86:87], v[86:87], v[72:73]
    v_exp_f32 v76, v76
    v_exp_f32 v77, v77
    v_pk_fma_f32 v[80:81], v[80:81], s[64:65], v[84:85] op_sel_hi:[1,0,0] neg_lo:[0,0,1] neg_hi:[0,0,1]
    v_pk_add_f32 v[86:87], v[86:87], v[74:75]
    v_exp_f32 v78, v78
    v_exp_f32 v79, v79
    v_pk_fma_f32 v[82:83], v[82:83], s[64:65], v[84:85] op_sel_hi:[1,0,0] neg_lo:[0,0,1] neg_hi:[0,0,1]
    v_pk_add_f32 v[86:87], v[86:87], v[76:77]
    v_exp_f32 v80, v80
    v_exp_f32 v81, v81
    v_pk_add_f32 v[86:87], v[86:87], v[78:79]
    v_exp_f32 v82, v82
    v_exp_f32 v83, v83
    v_pk_add_f32 v[86:87], v[86:87], v[80:81]
    v_pk_add_f32 v[86:87], v[86:87], v[82:83]
    v_add_f32_e64 v86, v86, v87
    v_rcp_f32 v86, v86
    s_nop 0
    v_pk_mul_f32 v[64:65], v[64:65], v[86:87] op_sel_hi:[1,0]
    v_pk_mul_f32 v[66:67], v[66:67], v[86:87] op_sel_hi:[1,0]
    v_pk_mul_f32 v[68:69], v[68:69], v[86:87] op_sel_hi:[1,0]
    v_cvt_pk_bf16_f32 v140, v64, v65
    v_pk_mul_f32 v[70:71], v[70:71], v[86:87] op_sel_hi:[1,0]
    v_cvt_pk_bf16_f32 v141, v66, v67
    v_pk_mul_f32 v[72:73], v[72:73], v[86:87] op_sel_hi:[1,0]
    v_cvt_pk_bf16_f32 v142, v68, v69
    v_pk_mul_f32 v[74:75], v[74:75], v[86:87] op_sel_hi:[1,0]
    v_cvt_pk_bf16_f32 v143, v70, v71
    v_pk_mul_f32 v[76:77], v[76:77], v[86:87] op_sel_hi:[1,0]
    v_cvt_pk_bf16_f32 v144, v72, v73
    v_pk_mul_f32 v[78:79], v[78:79], v[86:87] op_sel_hi:[1,0]
    v_cvt_pk_bf16_f32 v145, v74, v75
    v_pk_mul_f32 v[80:81], v[80:81], v[86:87] op_sel_hi:[1,0]
    v_cvt_pk_bf16_f32 v146, v76, v77
    v_pk_mul_f32 v[82:83], v[82:83], v[86:87] op_sel_hi:[1,0]
    v_cvt_pk_bf16_f32 v147, v78, v79
    v_cvt_pk_bf16_f32 v148, v80, v81
    v_cvt_pk_bf16_f32 v149, v82, v83
    v_mov_b32 v150, 0
    v_mov_b32 v151, 0
    v_max3_f32 v116, v96, v97, v98
    v_max3_f32 v117, v99, v100, v101
    v_max3_f32 v116, v116, v102, v103
    v_max3_f32 v117, v117, v104, v105
    v_max3_f32 v116, v116, v106, v107
    v_max3_f32 v117, v117, v108, v109
    v_max3_f32 v116, v116, v110, v111
    v_max3_f32 v117, v117, v112, v113
    v_max3_f32 v116, v116, v114, v115
    v_max_f32 v116, v116, v117
    v_mul_f32 v116, s64, v116
    v_pk_fma_f32 v[96:97], v[96:97], s[64:65], v[116:117] op_sel_hi:[1,0,0] neg_lo:[0,0,1] neg_hi:[0,0,1]
    v_pk_fma_f32 v[98:99], v[98:99], s[64:65], v[116:117] op_sel_hi:[1,0,0] neg_lo:[0,0,1] neg_hi:[0,0,1]
    v_exp_f32 v96, v96
    v_exp_f32 v97, v97
    v_pk_fma_f32 v[100:101], v[100:101], s[64:65], v[116:117] op_sel_hi:[1,0,0] neg_lo:[0,0,1] neg_hi:[0,0,1]
    v_exp_f32 v98, v98
    v_exp_f32 v99, v99
    v_pk_fma_f32 v[102:103], v[102:103], s[64:65], v[116:117] op_sel_hi:[1,0,0] neg_lo:[0,0,1] neg_hi:[0,0,1]
    v_exp_f32 v100, v100
    v_exp_f32 v101, v101
    v_pk_fma_f32 v[104:105], v[104:105], s[64:65], v[116:117] op_sel_hi:[1,0,0] neg_lo:[0,0,1] neg_hi:[0,0,1]
    v_pk_add_f32 v[118:119], v[96:97], v[98:99]
    v_exp_f32 v102, v102
    v_exp_f32 v103, v103
    v_pk_fma_f32 v[106:107], v[106:107], s[64:65], v[116:117] op_sel_hi:[1,0,0] neg_lo:[0,0,1] neg_hi:[0,0,1]
    v_pk_add_f32 v[118:119], v[118:119], v[100:101]
    v_exp_f32 v104, v104
    v_exp_f32 v105, v105
    v_pk_fma_f32 v[108:109], v[108:109], s[64:65], v[116:117] op_sel_hi:[1,0,0] neg_lo:[0,0,1] neg_hi:[0,0,1]
    v_pk_add_f32 v[118:119], v[118:119], v[102:103]
    v_exp_f32 v106, v106
    v_exp_f32 v107, v107
    v_pk_fma_f32 v[110:111], v[110:111], s[64:65], v[116:117] op_sel_hi:[1,0,0] neg_lo:[0,0,1] neg_hi:[0,0,1]
    v_pk_add_f32 v[118:119], v[118:119], v[104:105]
    v_exp_f32 v108, v108
    v_exp_f32 v109, v109
    v_pk_fma_f32 v[112:113], v[112:113], s[64:65], v[116:117] op_sel_hi:[1,0,0] neg_lo:[0,0,1] neg_hi:[0,0,1]
    v_pk_add_f32 v[118:119], v[118:119], v[106:107]
    v_exp_f32 v110, v110
    v_exp_f32 v111, v111
    v_pk_fma_f32 v[114:115], v[114:115], s[64:65], v[116:117] op_sel_hi:[1,0,0] neg_lo:[0,0,1] neg_hi:[0,0,1]
    v_pk_add_f32 v[118:119], v[118:119], v[108:109]
    v_exp_f32 v112, v112
    v_exp_f32 v113, v113
    v_pk_add_f32 v[118:119], v[118:119], v[110:111]
    v_exp_f32 v114, v114
    v_exp_f32 v115, v115
    v_pk_add_f32 v[118:119], v[118:119], v[112:113]
    v_pk_add_f32 v[118:119], v[118:119], v[114:115]
    v_add_f32_e64 v118, v118, v119
    v_rcp_f32 v118, v118
    s_nop 0
    v_pk_mul_f32 v[96:97], v[96:97], v[118:119] op_sel_hi:[1,0]
    v_pk_mul_f32 v[98:99], v[98:99], v[118:119] op_sel_hi:[1,0]
    v_pk_mul_f32 v[100:101], v[100:101], v[118:119] op_sel_hi:[1,0]
    v_cvt_pk_bf16_f32 v152, v96, v97
    v_pk_mul_f32 v[102:103], v[102:103], v[118:119] op_sel_hi:[1,0]
    v_cvt_pk_bf16_f32 v153, v98, v99
    v_pk_mul_f32 v[104:105], v[104:105], v[118:119] op_sel_hi:[1,0]
    v_cvt_pk_bf16_f32 v154, v100, v101
    v_pk_mul_f32 v[106:107], v[106:107], v[118:119] op_sel_hi:[1,0]
    v_cvt_pk_bf16_f32 v155, v102, v103
    v_pk_mul_f32 v[108:109], v[108:109], v[118:119] op_sel_hi:[1,0]
    v_cvt_pk_bf16_f32 v156, v104, v105
    v_pk_mul_f32 v[110:111], v[110:111], v[118:119] op_sel_hi:[1,0]
    v_cvt_pk_bf16_f32 v157, v106, v107
    v_pk_mul_f32 v[112:113], v[112:113], v[118:119] op_sel_hi:[1,0]
    v_cvt_pk_bf16_f32 v158, v108, v109
    v_pk_mul_f32 v[114:115], v[114:115], v[118:119] op_sel_hi:[1,0]
    v_cvt_pk_bf16_f32 v159, v110, v111
    v_cvt_pk_bf16_f32 v160, v112, v113
    v_cvt_pk_bf16_f32 v161, v114, v115
    v_mov_b32 v162, 0
    v_mov_b32 v163, 0
    v_mov_b32 v194, 0
    v_mov_b32 v195, 0
    s_mov_b32 s71, 0x358637bd
    s_setprio 2
    s_waitcnt lgkmcnt(0)
    s_barrier
    s_nop 0
    ds_read_b64 v[184:185], v24
    ds_read_b64 v[186:187], v25
    ds_read_b64 v[188:189], v26
    ds_read_b64 v[190:191], v27
    ds_read_b64 v[192:193], v28
    s_waitcnt lgkmcnt(3)
    v_mfma_f32_32x32x16_bf16 v[32:47], v[184:187], v[128:131], 0
    s_waitcnt lgkmcnt(1)
    v_mfma_f32_32x32x16_bf16 v[32:47], v[188:191], v[132:135], v[32:47]
    s_waitcnt lgkmcnt(0)
    v_mfma_f32_32x32x16_bf16 v[32:47], v[192:195], v[136:139], v[32:47]
    v_mfma_f32_32x32x16_bf16 v[48:63], v[184:187], v[140:143], 0
    v_mfma_f32_32x32x16_bf16 v[48:63], v[188:191], v[144:147], v[48:63]
    s_nop 5
    v_mfma_f32_32x32x16_bf16 v[48:63], v[192:195], v[148:151], v[48:63]
    s_nop 2
    v_mfma_f32_32x32x16_bf16 v[64:79], v[184:187], v[152:155], 0
    v_add_f32 v44, s71, v44
    v_rcp_f32 v44, v44
    s_nop 0
    v_pk_mul_f32 v[32:33], v[32:33], v[44:45] op_sel_hi:[1,0]
    v_pk_mul_f32 v[34:35], v[34:35], v[44:45] op_sel_hi:[1,0]
    v_pk_mul_f32 v[36:37], v[36:37], v[44:45] op_sel_hi:[1,0]
    v_mfma_f32_32x32x16_bf16 v[64:79], v[188:191], v[156:159], v[64:79]
    v_pk_mul_f32 v[38:39], v[38:39], v[44:45] op_sel_hi:[1,0]
    v_pk_mul_f32 v[40:41], v[40:41], v[44:45] op_sel_hi:[1,0]
    v_pk_mul_f32 v[42:43], v[42:43], v[44:45] op_sel_hi:[1,0]
    v_cvt_pk_bf16_f32 v216, v32, v33
    v_cvt_pk_bf16_f32 v217, v34, v35
    v_mfma_f32_32x32x16_bf16 v[64:79], v[192:195], v[160:163], v[64:79]
    v_cvt_pk_bf16_f32 v218, v36, v37
    v_cvt_pk_bf16_f32 v219, v38, v39
    v_cvt_pk_bf16_f32 v220, v40, v41
    v_cvt_pk_bf16_f32 v221, v42, v43
    buffer_store_dwordx4 v[216:219], v253, s[52:55], s62 offen sc1
    v_add_f32_e64 v60, s71, v60
    v_rcp_f32 v60, v60
    s_nop 0
    v_pk_mul_f32 v[48:49], v[48:49], v[60:61] op_sel_hi:[1,0]
    v_pk_mul_f32 v[50:51], v[50:51], v[60:61] op_sel_hi:[1,0]
    v_pk_mul_f32 v[52:53], v[52:53], v[60:61] op_sel_hi:[1,0]
    v_pk_mul_f32 v[54:55], v[54:55], v[60:61] op_sel_hi:[1,0]
    v_pk_mul_f32 v[56:57], v[56:57], v[60:61] op_sel_hi:[1,0]
    v_pk_mul_f32 v[58:59], v[58:59], v[60:61] op_sel_hi:[1,0]
    v_cvt_pk_bf16_f32 v224, v48, v49
    v_cvt_pk_bf16_f32 v225, v50, v51
    v_cvt_pk_bf16_f32 v226, v52, v53
    v_cvt_pk_bf16_f32 v227, v54, v55
    v_cvt_pk_bf16_f32 v228, v56, v57
    v_cvt_pk_bf16_f32 v229, v58, v59
    buffer_store_dwordx4 v[224:227], v253, s[52:55], s68 offen sc1
    v_add_f32 v76, s71, v76
    v_rcp_f32 v76, v76
    v_cndmask_b32 v220, v220, v228, s[66:67]
    v_cndmask_b32 v221, v221, v229, s[66:67]
    v_pk_mul_f32 v[72:73], v[72:73], v[76:77] op_sel_hi:[1,0]
    v_pk_mul_f32 v[74:75], v[74:75], v[76:77] op_sel_hi:[1,0]
    v_pk_mul_f32 v[64:65], v[64:65], v[76:77] op_sel_hi:[1,0]
    v_pk_mul_f32 v[66:67], v[66:67], v[76:77] op_sel_hi:[1,0]
    v_pk_mul_f32 v[68:69], v[68:69], v[76:77] op_sel_hi:[1,0]
    v_pk_mul_f32 v[70:71], v[70:71], v[76:77] op_sel_hi:[1,0]
    v_cvt_pk_bf16_f32 v222, v72, v73
    v_cvt_pk_bf16_f32 v223, v74, v75
    v_cvt_pk_bf16_f32 v232, v64, v65
    v_cvt_pk_bf16_f32 v233, v66, v67
    v_cvt_pk_bf16_f32 v234, v68, v69
    v_cvt_pk_bf16_f32 v235, v70, v71
    v_permlane16_swap_b32 v220, v222
    v_permlane16_swap_b32 v221, v223
    buffer_store_dwordx4 v[232:235], v253, s[52:55], s69 offen sc1
    buffer_store_dwordx4 v[220:223], v254, s[52:55], 0 offen offset:1024 sc1
    s_cmp_ge_u32 s5, 20
    s_cbranch_scc1 L_c_done
    s_mov_b32 s63, 0
    s_mov_b64 s[44:45], -1
L_c_g2:
    s_cmp_ge_u32 s5, 10
    s_cselect_b32 s39, 10, 0
    s_cselect_b32 s40, 4, 0
    s_sub_u32 s39, s5, s39
    s_lshl_b32 s41, s4, 3
    s_add_u32 s41, s41, s40
    s_add_u32 s41, s41, s3
    s_lshr_b32 s40, s41, 1
    s_xor_b32 s40, s40, s41
    s_bfe_u32 s40, s40, 0x10004
    s_and_b32 s70, s41, 31
    s_lshl4_add_u32 s70, s70, s40
    s_lshl_b32 s70, s70, 13
    s_bitcmp1_b32 s41, 0
    s_cselect_b32 s40, 3072, 0
    s_add_u32 s70, s70, s40
    s_cmp_ge_u32 s41, 64
    s_cselect_b32 s70, 2130706432, s70
    s_mul_i32 s49, s41, 10923
    s_and_b32 s49, s49, 0xffff0000
    s_cmp_ge_u32 s41, 30
    s_cselect_b32 s40, 0x2000, 0
    s_add_u32 s49, s49, s40
    s_mul_i32 s41, s41, 81920
    s_lshl_b32 s39, s39, 7
    s_add_u32 s41, s41, s39
    v_lshlrev_b32 v2, 4, v1
    v_and_b32_e64 v14, 31, v1
    v_lshrrev_b32 v15, 5, v1
    v_lshrrev_b32 v16, 4, v1
    v_mul_u32_u24 v16, 1280, v16
    v_and_b32_e64 v17, 15, v1
    v_lshl_add_u32 v3, v17, 4, v16
    v_and_b32 v19, 13, v17
    v_lshlrev_b32 v19, 12, v19
    v_bfe_u32 v20, v17, 1, 1
    v_lshl_add_u32 v19, v20, 6, v19
    v_mov_b32_e64 v20, 0
    s_mul_i32 s39, s3, 4608
    v_mul_u32_u24 v16, 144, v14
    v_lshl_add_u32 v16, v15, 5, v16
    v_add_u32 v8, s39, v16
    v_lshrrev_b32 v16, 3, v1
    v_and_b32 v17, 7, v1
    v_lshlrev_b32 v17, 4, v17
    v_mul_u32_u24 v18, 144, v16
    v_add3_u32 v9, v17, v18, s39
    v_mul_u32_u24 v18, 2560, v16
    v_add3_u32 v10, v17, v18, s41
    v_add_u32 v11, 20480, v10
    v_add_u32 v12, 40960, v10
    v_add_u32 v13, 61440, v10
    v_bfe_u32 v14, v1, 2, 2
    v_and_b32_e64 v16, 1, v1
    v_bfe_u32 v17, v1, 4, 1
    v_lshl_add_u32 v16, v16, 1, v17
    v_bfe_u32 v17, v1, 1, 1
    v_lshl_add_u32 v16, v16, 1, v17
    v_bfe_u32 v17, v1, 3, 1
    v_lshl_add_u32 v16, v17, 3, v16
    v_lshlrev_b32_e64 v16, 3, v16
    v_lshl_add_u32 v16, v14, 7, v16
    v_add_u32 v16, 77824, v16
    v_lshl_add_u32 v4, v15, 10, v16
    v_xor_b32_e64 v5, 64, v4
    v_mul_u32_u24 v15, 5120, v15
    v_add_u32 v6, v15, v16
    v_xor_b32 v7, 64, v6
    s_add_u32 s73, s70, 16384
    s_add_u32 s74, s70, 32768
    s_add_u32 s75, s70, 49152
    s_add_u32 s76, s70, 65536
    s_add_u32 s77, s70, 81920
    s_add_u32 s78, s70, 98304
    s_add_u32 s79, s70, 114688
    ds_read_b64_tr_b16 v[64:65], v4 offset:0
    ds_read_b64_tr_b16 v[66:67], v4 offset:512
    ds_read_b64_tr_b16 v[68:69], v5 offset:0
    ds_read_b64_tr_b16 v[70:71], v5 offset:512
    ds_read_b64_tr_b16 v[72:73], v4 offset:2560
    ds_read_b64_tr_b16 v[74:75], v4 offset:3072
    ds_read_b64_tr_b16 v[76:77], v5 offset:2560
    ds_read_b64_tr_b16 v[78:79], v5 offset:3072
    ds_read_b64_tr_b16 v[80:81], v4 offset:5120
    ds_read_b64_tr_b16 v[82:83], v4 offset:5632
    ds_read_b64_tr_b16 v[84:85], v5 offset:5120
    ds_read_b64_tr_b16 v[86:87], v5 offset:5632
    ds_read_b64_tr_b16 v[88:89], v4 offset:7680
    ds_read_b64_tr_b16 v[90:91], v4 offset:8192
    ds_read_b64_tr_b16 v[92:93], v5 offset:7680
    ds_read_b64_tr_b16 v[94:95], v5 offset:8192
    ds_read_b64_tr_b16 v[96:97], v6 offset:2048
    ds_read_b64_tr_b16 v[98:99], v6 offset:4608
    ds_read_b64_tr_b16 v[100:101], v7 offset:2048
    ds_read_b64_tr_b16 v[102:103], v7 offset:4608
    ds_read_b64_tr_b16 v[104:105], v4 offset:10240
    ds_read_b64_tr_b16 v[106:107], v4 offset:10752
    ds_read_b64_tr_b16 v[108:109], v5 offset:10240
    ds_read_b64_tr_b16 v[110:111], v5 offset:10752
    s_mov_b64 s[50:51], 0xffff
L_c_poll:
    s_mov_b64 exec, s[50:51]
    buffer_load_dword v20, v19, s[56:59], s49 offen offset:3968 sc1
    s_mov_b64 exec, -1
    s_sleep 1
    s_add_u32 s63, s63, 1
    s_waitcnt vmcnt(0)
    v_cmp_eq_u32 s[50:51], -1, v20
    s_cmp_ge_u32 s63, 4194304
    s_cselect_b32 s50, 0, s50
    s_cmp_lg_u32 s50, 0
    s_cbranch_scc1 L_c_poll
    buffer_load_dwordx4 v[192:195], v2, s[52:55], s70 offen offset:0 sc1
    buffer_load_dwordx4 v[196:199], v2, s[52:55], s70 offen offset:1280 sc1
    buffer_load_dwordx4 v[200:203], v2, s[52:55], s70 offen offset:2560 sc1
    buffer_load_dwordx4 v[204:207], v2, s[52:55], s70 offen offset:3840 sc1
    buffer_load_dwordx4 v[208:211], v3, s[52:55], s70 offen offset:1024 sc1
    ds_read_b64_tr_b16 v[112:113], v4 offset:12800
    ds_read_b64_tr_b16 v[114:115], v4 offset:13312
    ds_read_b64_tr_b16 v[116:117], v5 offset:12800
    ds_read_b64_tr_b16 v[118:119], v5 offset:13312
    ds_read_b64_tr_b16 v[120:121], v4 offset:15360
    ds_read_b64_tr_b16 v[122:123], v4 offset:15872
    ds_read_b64_tr_b16 v[124:125], v5 offset:15360
    ds_read_b64_tr_b16 v[126:127], v5 offset:15872
    ds_read_b64_tr_b16 v[128:129], v4 offset:17920
    ds_read_b64_tr_b16 v[130:131], v4 offset:18432
    ds_read_b64_tr_b16 v[132:133], v5 offset:17920
    ds_read_b64_tr_b16 v[134:135], v5 offset:18432
    ds_read_b64_tr_b16 v[136:137], v6 offset:12288
    ds_read_b64_tr_b16 v[138:139], v6 offset:14848
    ds_read_b64_tr_b16 v[140:141], v7 offset:12288
    ds_read_b64_tr_b16 v[142:143], v7 offset:14848
    ds_read_b64_tr_b16 v[144:145], v4 offset:20480
    ds_read_b64_tr_b16 v[146:147], v4 offset:20992
    ds_read_b64_tr_b16 v[148:149], v5 offset:20480
    ds_read_b64_tr_b16 v[150:151], v5 offset:20992
    buffer_load_dwordx4 v[212:215], v2, s[52:55], s73 offen offset:0 sc1
    buffer_load_dwordx4 v[216:219], v2, s[52:55], s73 offen offset:1280 sc1
    buffer_load_dwordx4 v[220:223], v2, s[52:55], s73 offen offset:2560 sc1
    buffer_load_dwordx4 v[224:227], v2, s[52:55], s73 offen offset:3840 sc1
    buffer_load_dwordx4 v[228:231], v3, s[52:55], s73 offen offset:1024 sc1
    ds_read_b64_tr_b16 v[152:153], v4 offset:23040
    ds_read_b64_tr_b16 v[154:155], v4 offset:23552
    ds_read_b64_tr_b16 v[156:157], v5 offset:23040
    ds_read_b64_tr_b16 v[158:159], v5 offset:23552
    ds_read_b64_tr_b16 v[160:161], v4 offset:25600
    ds_read_b64_tr_b16 v[162:163], v4 offset:26112
    ds_read_b64_tr_b16 v[164:165], v5 offset:25600
    ds_read_b64_tr_b16 v[166:167], v5 offset:26112
    ds_read_b64_tr_b16 v[168:169], v4 offset:28160
    ds_read_b64_tr_b16 v[170:171], v4 offset:28672
    ds_read_b64_tr_b16 v[172:173], v5 offset:28160
    ds_read_b64_tr_b16 v[174:175], v5 offset:28672
    ds_read_b64_tr_b16 v[176:177], v6 offset:22528
    ds_read_b64_tr_b16 v[178:179], v6 offset:25088
    ds_read_b64_tr_b16 v[180:181], v7 offset:22528
    ds_read_b64_tr_b16 v[182:183], v7 offset:25088
    ds_read_b64_tr_b16 v[184:185], v4 offset:30720
    ds_read_b64_tr_b16 v[186:187], v4 offset:31232
    ds_read_b64_tr_b16 v[188:189], v5 offset:30720
    ds_read_b64_tr_b16 v[190:191], v5 offset:31232
    s_waitcnt vmcnt(5)
    v_max3_u32 v14, v208, v192, v196
    v_max3_u32 v14, v14, v200, v204
    v_cmp_eq_u32_e64 vcc, -1, v14
    s_nop 0
    s_cbranch_vccnz L_c_fail0
L_c_ok0:
    s_waitcnt lgkmcnt(14)
    v_mfma_f32_32x32x16_bf16 v[32:47], v[64:67], v[192:195], 0
    buffer_load_dwordx4 v[232:235], v2, s[52:55], s74 offen offset:0 sc1
    v_permlane16_swap_b32 v208, v210
    v_mfma_f32_32x32x16_bf16 v[48:63], v[68:71], v[192:195], 0
    ds_read_b64_tr_b16 v[64:65], v4 offset:33280
    ds_read_b64_tr_b16 v[66:67], v4 offset:33792
    buffer_load_dwordx4 v[236:239], v2, s[52:55], s74 offen offset:1280 sc1
    v_permlane16_swap_b32 v209, v211
    v_mfma_f32_32x32x16_bf16 v[32:47], v[72:75], v[196:199], v[32:47]
    ds_read_b64_tr_b16 v[68:69], v5 offset:33280
    ds_read_b64_tr_b16 v[70:71], v5 offset:33792
    buffer_load_dwordx4 v[240:243], v2, s[52:55], s74 offen offset:2560 sc1
    v_mfma_f32_32x32x16_bf16 v[48:63], v[76:79], v[196:199], v[48:63]
    ds_read_b64_tr_b16 v[72:73], v4 offset:35840
    buffer_load_dwordx4 v[244:247], v2, s[52:55], s74 offen offset:3840 sc1
    v_mfma_f32_32x32x16_bf16 v[32:47], v[80:83], v[200:203], v[32:47]
    ds_read_b64_tr_b16 v[74:75], v4 offset:36352
    ds_read_b64_tr_b16 v[76:77], v5 offset:35840
    buffer_load_dwordx4 v[248:251], v3, s[52:55], s74 offen offset:1024 sc1
    v_mfma_f32_32x32x16_bf16 v[48:63], v[84:87], v[200:203], v[48:63]
    ds_read_b64_tr_b16 v[78:79], v5 offset:36352
    v_mfma_f32_32x32x16_bf16 v[32:47], v[88:91], v[204:207], v[32:47]
    ds_read_b64_tr_b16 v[80:81], v4 offset:38400
    ds_read_b64_tr_b16 v[82:83], v4 offset:38912
    v_mfma_f32_32x32x16_bf16 v[48:63], v[92:95], v[204:207], v[48:63]
    ds_read_b64_tr_b16 v[84:85], v5 offset:38400
    s_waitcnt vmcnt(5)
    v_max3_u32 v14, v228, v212, v216
    v_max3_u32 v14, v14, v220, v224
    v_mfma_f32_32x32x16_bf16 v[32:47], v[96:99], v[208:211], v[32:47]
    ds_read_b64_tr_b16 v[86:87], v5 offset:38912
    ds_read_b64_tr_b16 v[88:89], v6 offset:32768
    v_cmp_eq_u32 vcc, -1, v14
    v_mfma_f32_32x32x16_bf16 v[48:63], v[100:103], v[208:211], v[48:63]
    ds_read_b64_tr_b16 v[90:91], v6 offset:35328
    s_cbranch_vccnz L_c_fail1
L_c_ok1:
    v_mfma_f32_32x32x16_bf16 v[32:47], v[104:107], v[212:215], v[32:47]
    ds_read_b64_tr_b16 v[92:93], v7 offset:32768
    ds_read_b64_tr_b16 v[94:95], v7 offset:35328
    buffer_load_dwordx4 v[192:195], v2, s[52:55], s75 offen offset:0 sc1
    v_permlane16_swap_b32 v228, v230
    v_mfma_f32_32x32x16_bf16 v[48:63], v[108:111], v[212:215], v[48:63]
    ds_read_b64_tr_b16 v[96:97], v4 offset:40960
    buffer_load_dwordx4 v[196:199], v2, s[52:55], s75 offen offset:1280 sc1
    v_permlane16_swap_b32 v229, v231
    v_mfma_f32_32x32x16_bf16 v[32:47], v[112:115], v[216:219], v[32:47]
    ds_read_b64_tr_b16 v[98:99], v4 offset:41472
    ds_read_b64_tr_b16 v[100:101], v5 offset:40960
    buffer_load_dwordx4 v[200:203], v2, s[52:55], s75 offen offset:2560 sc1
    v_mfma_f32_32x32x16_bf16 v[48:63], v[116:119], v[216:219], v[48:63]
    ds_read_b64_tr_b16 v[102:103], v5 offset:41472
    buffer_load_dwordx4 v[204:207], v2, s[52:55], s75 offen offset:3840 sc1
    v_mfma_f32_32x32x16_bf16 v[32:47], v[120:123], v[220:223], v[32:47]
    ds_read_b64_tr_b16 v[104:105], v4 offset:43520
    ds_read_b64_tr_b16 v[106:107], v4 offset:44032
    buffer_load_dwordx4 v[208:211], v3, s[52:55], s75 offen offset:1024 sc1
    v_mfma_f32_32x32x16_bf16 v[48:63], v[124:127], v[220:223], v[48:63]
    ds_read_b64_tr_b16 v[108:109], v5 offset:43520
    v_mfma_f32_32x32x16_bf16 v[32:47], v[128:131], v[224:227], v[32:47]
    ds_read_b64_tr_b16 v[110:111], v5 offset:44032
    ds_read_b64_tr_b16 v[112:113], v4 offset:46080
    v_mfma_f32_32x32x16_bf16 v[48:63], v[132:135], v[224:227], v[48:63]
    ds_read_b64_tr_b16 v[114:115], v4 offset:46592
    s_waitcnt vmcnt(5)
    v_max3_u32 v14, v248, v232, v236
    v_max3_u32 v14, v14, v240, v244
    v_mfma_f32_32x32x16_bf16 v[32:47], v[136:139], v[228:231], v[32:47]
    ds_read_b64_tr_b16 v[116:117], v5 offset:46080
    v_cmp_eq_u32_e64 vcc, -1, v14
    v_mfma_f32_32x32x16_bf16 v[48:63], v[140:143], v[228:231], v[48:63]
    ds_read_b64_tr_b16 v[118:119], v5 offset:46592
    ds_read_b64_tr_b16 v[120:121], v4 offset:48640
    s_cbranch_vccnz L_c_fail2
L_c_ok2:
    v_mfma_f32_32x32x16_bf16 v[32:47], v[144:147], v[232:235], v[32:47]
    ds_read_b64_tr_b16 v[122:123], v4 offset:49152
    buffer_load_dwordx4 v[212:215], v2, s[52:55], s76 offen offset:0 sc1
    v_permlane16_swap_b32 v248, v250
    v_mfma_f32_32x32x16_bf16 v[48:63], v[148:151], v[232:235], v[48:63]
    ds_read_b64_tr_b16 v[124:125], v5 offset:48640
    ds_read_b64_tr_b16 v[126:127], v5 offset:49152
    buffer_load_dwordx4 v[216:219], v2, s[52:55], s76 offen offset:1280 sc1
    v_permlane16_swap_b32 v249, v251
    v_mfma_f32_32x32x16_bf16 v[32:47], v[152:155], v[236:239], v[32:47]
    ds_read_b64_tr_b16 v[128:129], v6 offset:43008
    buffer_load_dwordx4 v[220:223], v2, s[52:55], s76 offen offset:2560 sc1
    v_mfma_f32_32x32x16_bf16 v[48:63], v[156:159], v[236:239], v[48:63]
    ds_read_b64_tr_b16 v[130:131], v6 offset:45568
    ds_read_b64_tr_b16 v[132:133], v7 offset:43008
    buffer_load_dwordx4 v[224:227], v2, s[52:55], s76 offen offset:3840 sc1
    v_mfma_f32_32x32x16_bf16 v[32:47], v[160:163], v[240:243], v[32:47]
    ds_read_b64_tr_b16 v[134:135], v7 offset:45568
    buffer_load_dwordx4 v[228:231], v3, s[52:55], s76 offen offset:1024 sc1
    s_waitcnt lgkmcnt(9)
    v_mfma_f32_32x32x16_bf16 v[48:63], v[164:167], v[240:243], v[48:63]
    ds_read_b64_tr_b16 v[136:137], v4 offset:51200
    ds_read_b64_tr_b16 v[138:139], v4 offset:51712
    v_mfma_f32_32x32x16_bf16 v[32:47], v[168:171], v[244:247], v[32:47]
    ds_read_b64_tr_b16 v[140:141], v5 offset:51200
    v_mfma_f32_32x32x16_bf16 v[48:63], v[172:175], v[244:247], v[48:63]
    ds_read_b64_tr_b16 v[142:143], v5 offset:51712
    ds_read_b64_tr_b16 v[144:145], v4 offset:53760
    s_waitcnt vmcnt(5)
    v_max3_u32 v14, v208, v192, v196
    v_max3_u32 v14, v14, v200, v204
    v_mfma_f32_32x32x16_bf16 v[32:47], v[176:179], v[248:251], v[32:47]
    ds_read_b64_tr_b16 v[146:147], v4 offset:54272
    v_cmp_eq_u32 vcc, -1, v14
    v_mfma_f32_32x32x16_bf16 v[48:63], v[180:183], v[248:251], v[48:63]
    ds_read_b64_tr_b16 v[148:149], v5 offset:53760
    ds_read_b64_tr_b16 v[150:151], v5 offset:54272
    s_cbranch_vccnz L_c_fail3
L_c_ok3:
    v_mfma_f32_32x32x16_bf16 v[32:47], v[184:187], v[192:195], v[32:47]
    ds_read_b64_tr_b16 v[152:153], v4 offset:56320
    buffer_load_dwordx4 v[232:235], v2, s[52:55], s77 offen offset:0 sc1
    v_permlane16_swap_b32 v208, v210
    v_mfma_f32_32x32x16_bf16 v[48:63], v[188:191], v[192:195], v[48:63]
    ds_read_b64_tr_b16 v[154:155], v4 offset:56832
    ds_read_b64_tr_b16 v[156:157], v5 offset:56320
    buffer_load_dwordx4 v[236:239], v2, s[52:55], s77 offen offset:1280 sc1
    v_permlane16_swap_b32 v209, v211
    v_mfma_f32_32x32x16_bf16 v[32:47], v[64:67], v[196:199], v[32:47]
    ds_read_b64_tr_b16 v[158:159], v5 offset:56832
    buffer_load_dwordx4 v[240:243], v2, s[52:55], s77 offen offset:2560 sc1
    v_mfma_f32_32x32x16_bf16 v[48:63], v[68:71], v[196:199], v[48:63]
    ds_read_b64_tr_b16 v[160:161], v4 offset:58880
    ds_read_b64_tr_b16 v[162:163], v4 offset:59392
    buffer_load_dwordx4 v[244:247], v2, s[52:55], s77 offen offset:3840 sc1
    v_mfma_f32_32x32x16_bf16 v[32:47], v[72:75], v[200:203], v[32:47]
    ds_read_b64_tr_b16 v[164:165], v5 offset:58880
    buffer_load_dwordx4 v[248:251], v3, s[52:55], s77 offen offset:1024 sc1
    v_mfma_f32_32x32x16_bf16 v[48:63], v[76:79], v[200:203], v[48:63]
    ds_read_b64_tr_b16 v[166:167], v5 offset:59392
    v_mfma_f32_32x32x16_bf16 v[32:47], v[80:83], v[204:207], v[32:47]
    ds_read_b64_tr_b16 v[168:169], v6 offset:53248
    ds_read_b64_tr_b16 v[170:171], v6 offset:55808
    v_mfma_f32_32x32x16_bf16 v[48:63], v[84:87], v[204:207], v[48:63]
    ds_read_b64_tr_b16 v[172:173], v7 offset:53248
    s_waitcnt vmcnt(5)
    v_max3_u32 v14, v228, v212, v216
    v_max3_u32 v14, v14, v220, v224
    v_mfma_f32_32x32x16_bf16 v[32:47], v[88:91], v[208:211], v[32:47]
    ds_read_b64_tr_b16 v[174:175], v7 offset:55808
    v_add_u32 v4, 61440, v4
    v_cmp_eq_u32_e64 vcc, -1, v14
    v_mfma_f32_32x32x16_bf16 v[48:63], v[92:95], v[208:211], v[48:63]
    v_add_u32 v5, 61440, v5
    s_cbranch_vccnz L_c_fail4
L_c_ok4:
    v_mfma_f32_32x32x16_bf16 v[32:47], v[96:99], v[212:215], v[32:47]
    v_add_u32 v6, 61440, v6
    v_add_u32 v7, 61440, v7
    buffer_load_dwordx4 v[192:195], v2, s[52:55], s78 offen offset:0 sc1
    v_permlane16_swap_b32 v228, v230
    v_mfma_f32_32x32x16_bf16 v[48:63], v[100:103], v[212:215], v[48:63]
    ds_read_b64_tr_b16 v[176:177], v4 offset:0
    buffer_load_dwordx4 v[196:199], v2, s[52:55], s78 offen offset:1280 sc1
    v_permlane16_swap_b32 v229, v231
    v_mfma_f32_32x32x16_bf16 v[32:47], v[104:107], v[216:219], v[32:47]
    ds_read_b64_tr_b16 v[178:179], v4 offset:512
    ds_read_b64_tr_b16 v[180:181], v5 offset:0
    buffer_load_dwordx4 v[200:203], v2, s[52:55], s78 offen offset:2560 sc1
    v_mfma_f32_32x32x16_bf16 v[48:63], v[108:111], v[216:219], v[48:63]
    ds_read_b64_tr_b16 v[182:183], v5 offset:512
    buffer_load_dwordx4 v[204:207], v2, s[52:55], s78 offen offset:3840 sc1
    v_mfma_f32_32x32x16_bf16 v[32:47], v[112:115], v[220:223], v[32:47]
    ds_read_b64_tr_b16 v[184:185], v4 offset:2560
    ds_read_b64_tr_b16 v[186:187], v4 offset:3072
    buffer_load_dwordx4 v[208:211], v3, s[52:55], s78 offen offset:1024 sc1
    s_waitcnt lgkmcnt(6)
    v_mfma_f32_32x32x16_bf16 v[48:63], v[116:119], v[220:223], v[48:63]
    ds_read_b64_tr_b16 v[188:189], v5 offset:2560
    v_mfma_f32_32x32x16_bf16 v[32:47], v[120:123], v[224:227], v[32:47]
    ds_read_b64_tr_b16 v[190:191], v5 offset:3072
    ds_read_b64_tr_b16 v[64:65], v4 offset:5120
    v_mfma_f32_32x32x16_bf16 v[48:63], v[124:127], v[224:227], v[48:63]
    ds_read_b64_tr_b16 v[66:67], v4 offset:5632
    s_waitcnt vmcnt(5)
    v_max3_u32 v14, v248, v232, v236
    v_max3_u32 v14, v14, v240, v244
    v_mfma_f32_32x32x16_bf16 v[32:47], v[128:131], v[228:231], v[32:47]
    ds_read_b64_tr_b16 v[68:69], v5 offset:5120
    ds_read_b64_tr_b16 v[70:71], v5 offset:5632
    v_cmp_eq_u32 vcc, -1, v14
    v_mfma_f32_32x32x16_bf16 v[48:63], v[132:135], v[228:231], v[48:63]
    ds_read_b64_tr_b16 v[72:73], v4 offset:7680
    s_cbranch_vccnz L_c_fail5
L_c_ok5:
    v_mfma_f32_32x32x16_bf16 v[32:47], v[136:139], v[232:235], v[32:47]
    ds_read_b64_tr_b16 v[74:75], v4 offset:8192
    ds_read_b64_tr_b16 v[76:77], v5 offset:7680
    buffer_load_dwordx4 v[212:215], v2, s[52:55], s79 offen offset:0 sc1
    v_permlane16_swap_b32 v248, v250
    v_mfma_f32_32x32x16_bf16 v[48:63], v[140:143], v[232:235], v[48:63]
    ds_read_b64_tr_b16 v[78:79], v5 offset:8192
    buffer_load_dwordx4 v[216:219], v2, s[52:55], s79 offen offset:1280 sc1
    v_permlane16_swap_b32 v249, v251
    v_mfma_f32_32x32x16_bf16 v[32:47], v[144:147], v[236:239], v[32:47]
    ds_read_b64_tr_b16 v[80:81], v6 offset:2048
    buffer_load_dwordx4 v[220:223], v2, s[52:55], s79 offen offset:2560 sc1
    v_mfma_f32_32x32x16_bf16 v[48:63], v[148:151], v[236:239], v[48:63]
    ds_read_b64_tr_b16 v[82:83], v6 offset:4608
    ds_read_b64_tr_b16 v[84:85], v7 offset:2048
    buffer_load_dwordx4 v[224:227], v2, s[52:55], s79 offen offset:3840 sc1
    v_mfma_f32_32x32x16_bf16 v[32:47], v[152:155], v[240:243], v[32:47]
    ds_read_b64_tr_b16 v[86:87], v7 offset:4608
    buffer_load_dwordx4 v[228:231], v3, s[52:55], s79 offen offset:1024 sc1
    v_mfma_f32_32x32x16_bf16 v[48:63], v[156:159], v[240:243], v[48:63]
    ds_read_b64_tr_b16 v[88:89], v4 offset:10240
    ds_read_b64_tr_b16 v[90:91], v4 offset:10752
    v_mfma_f32_32x32x16_bf16 v[32:47], v[160:163], v[244:247], v[32:47]
    ds_read_b64_tr_b16 v[92:93], v5 offset:10240
    v_mfma_f32_32x32x16_bf16 v[48:63], v[164:167], v[244:247], v[48:63]
    ds_read_b64_tr_b16 v[94:95], v5 offset:10752
    ds_read_b64_tr_b16 v[96:97], v4 offset:12800
    s_waitcnt vmcnt(5)
    v_max3_u32 v14, v208, v192, v196
    v_max3_u32 v14, v14, v200, v204
    v_mfma_f32_32x32x16_bf16 v[32:47], v[168:171], v[248:251], v[32:47]
    ds_read_b64_tr_b16 v[98:99], v4 offset:13312
    v_cmp_eq_u32_e64 vcc, -1, v14
    v_mfma_f32_32x32x16_bf16 v[48:63], v[172:175], v[248:251], v[48:63]
    ds_read_b64_tr_b16 v[100:101], v5 offset:12800
    ds_read_b64_tr_b16 v[102:103], v5 offset:13312
    s_cbranch_vccnz L_c_fail6
L_c_ok6:
    s_waitcnt lgkmcnt(9)
    v_mfma_f32_32x32x16_bf16 v[32:47], v[176:179], v[192:195], v[32:47]
    ds_read_b64_tr_b16 v[104:105], v4 offset:15360
    v_permlane16_swap_b32 v208, v210
    v_mfma_f32_32x32x16_bf16 v[48:63], v[180:183], v[192:195], v[48:63]
    ds_read_b64_tr_b16 v[106:107], v4 offset:15872
    ds_read_b64_tr_b16 v[108:109], v5 offset:15360
    v_permlane16_swap_b32 v209, v211
    v_mfma_f32_32x32x16_bf16 v[32:47], v[184:187], v[196:199], v[32:47]
    ds_read_b64_tr_b16 v[110:111], v5 offset:15872
    v_mfma_f32_32x32x16_bf16 v[48:63], v[188:191], v[196:199], v[48:63]
    ds_read_b64_tr_b16 v[112:113], v4 offset:17920
    ds_read_b64_tr_b16 v[114:115], v4 offset:18432
    v_mfma_f32_32x32x16_bf16 v[32:47], v[64:67], v[200:203], v[32:47]
    ds_read_b64_tr_b16 v[116:117], v5 offset:17920
    v_mfma_f32_32x32x16_bf16 v[48:63], v[68:71], v[200:203], v[48:63]
    ds_read_b64_tr_b16 v[118:119], v5 offset:18432
    ds_read_b64_tr_b16 v[120:121], v6 offset:12288
    v_mfma_f32_32x32x16_bf16 v[32:47], v[72:75], v[204:207], v[32:47]
    ds_read_b64_tr_b16 v[122:123], v6 offset:14848
    v_mfma_f32_32x32x16_bf16 v[48:63], v[76:79], v[204:207], v[48:63]
    ds_read_b64_tr_b16 v[124:125], v7 offset:12288
    ds_read_b64_tr_b16 v[126:127], v7 offset:14848
    s_waitcnt vmcnt(0)
    v_max3_u32 v14, v228, v212, v216
    v_max3_u32 v14, v14, v220, v224
    v_mfma_f32_32x32x16_bf16 v[32:47], v[80:83], v[208:211], v[32:47]
    v_cmp_eq_u32_e64 vcc, -1, v14
    s_waitcnt lgkmcnt(8)
    v_mfma_f32_32x32x16_bf16 v[48:63], v[84:87], v[208:211], v[48:63]
    s_cbranch_vccnz L_c_fail7
L_c_ok7:
    v_mfma_f32_32x32x16_bf16 v[32:47], v[88:91], v[212:215], v[32:47]
    v_permlane16_swap_b32 v228, v230
    v_mfma_f32_32x32x16_bf16 v[32:47], v[96:99], v[216:219], v[32:47]
    v_permlane16_swap_b32 v229, v231
    v_mfma_f32_32x32x16_bf16 v[32:47], v[104:107], v[220:223], v[32:47]
    s_waitcnt lgkmcnt(2)
    v_mfma_f32_32x32x16_bf16 v[32:47], v[112:115], v[224:227], v[32:47]
    v_mfma_f32_32x32x16_bf16 v[32:47], v[120:123], v[228:231], v[32:47]
    v_mfma_f32_32x32x16_bf16 v[48:63], v[92:95], v[212:215], v[48:63]
    s_nop 5
    v_mfma_f32_32x32x16_bf16 v[48:63], v[100:103], v[216:219], v[48:63]
    s_nop 3
    v_mfma_f32_32x32x16_bf16 v[48:63], v[108:111], v[220:223], v[48:63]
    v_cvt_pk_bf16_f32 v128, v32, v33
    v_cvt_pk_bf16_f32 v129, v34, v35
    v_cvt_pk_bf16_f32 v130, v36, v37
    v_cvt_pk_bf16_f32 v131, v38, v39
    ds_write_b128 v8, v[128:131] offset:0
    v_mfma_f32_32x32x16_bf16 v[48:63], v[116:119], v[224:227], v[48:63]
    v_cvt_pk_bf16_f32 v132, v40, v41
    v_cvt_pk_bf16_f32 v133, v42, v43
    v_cvt_pk_bf16_f32 v134, v44, v45
    v_cvt_pk_bf16_f32 v135, v46, v47
    ds_write_b128 v8, v[132:135] offset:16
    s_waitcnt lgkmcnt(2)
    v_mfma_f32_32x32x16_bf16 v[48:63], v[124:127], v[228:231], v[48:63]
    v_cmp_u_f32 vcc, v32, v32
    s_nop 0
    s_and_b64 vcc, vcc, s[44:45]
    s_cbranch_scc1 L_c_scan
    s_nop 7
    v_cvt_pk_bf16_f32 v136, v48, v49
    v_cvt_pk_bf16_f32 v137, v50, v51
    v_cvt_pk_bf16_f32 v138, v52, v53
    v_cvt_pk_bf16_f32 v139, v54, v55
    ds_write_b128 v8, v[136:139] offset:64
    v_cvt_pk_bf16_f32 v140, v56, v57
    v_cvt_pk_bf16_f32 v141, v58, v59
    v_cvt_pk_bf16_f32 v142, v60, v61
    v_cvt_pk_bf16_f32 v143, v62, v63
    ds_write_b128 v8, v[140:143] offset:80
    ds_read_b128 v[80:83], v9 offset:0
    ds_read_b128 v[84:87], v9 offset:1152
    ds_read_b128 v[88:91], v9 offset:2304
    ds_read_b128 v[92:95], v9 offset:3456
    s_waitcnt lgkmcnt(3)
    global_store_dwordx4 v10, v[80:83], s[30:31] sc1
    s_waitcnt lgkmcnt(2)
    global_store_dwordx4 v11, v[84:87], s[30:31] sc1
    s_waitcnt lgkmcnt(1)
    global_store_dwordx4 v12, v[88:91], s[30:31] sc1
    s_waitcnt lgkmcnt(0)
    global_store_dwordx4 v13, v[92:95], s[30:31] sc1
L_c_done:
    s_endpgm
L_l_clr:
    s_sleep 32
    global_load_dword v109, v108, s[32:33] sc1
    s_add_u32 s40, s40, 1
    s_waitcnt vmcnt(0)
    v_readfirstlane_b32 s41, v109
    s_nop 0
    s_and_b32 s39, s41, 0xffff
    s_cmp_ge_u32 s40, 4194304
    s_cselect_b32 s39, 48, s39
    s_cmp_lt_u32 s39, 48
    s_cbranch_scc1 L_l_clr
    s_branch L_l_clr_ok
L_l_again:
    s_mov_b64 exec, s[74:75]
    s_cbranch_execz L_l_sk0
    buffer_load_dwordx4 v[32:35], v98, s[56:59], 0 offen sc1
    buffer_load_dwordx4 v[36:39], v99, s[56:59], 0 offen sc1
    buffer_load_dwordx4 v[40:43], v100, s[56:59], 0 offen sc1
    buffer_load_dwordx4 v[44:47], v101, s[56:59], 0 offen sc1
L_l_sk0:
    s_mov_b64 exec, s[76:77]
    s_cbranch_execz L_l_sk1
    buffer_load_dwordx4 v[48:51], v98, s[56:59], s16 offen sc1
    buffer_load_dwordx4 v[52:55], v99, s[56:59], s16 offen sc1
    buffer_load_dwordx4 v[56:59], v100, s[56:59], s16 offen sc1
    buffer_load_dwordx4 v[60:63], v101, s[56:59], s16 offen sc1
L_l_sk1:
    s_mov_b64 exec, s[78:79]
    s_cbranch_execz L_l_sk2
    buffer_load_dwordx4 v[64:67], v98, s[56:59], s17 offen sc1
    buffer_load_dwordx4 v[68:71], v99, s[56:59], s17 offen sc1
    buffer_load_dwordx4 v[72:75], v100, s[56:59], s17 offen sc1
    buffer_load_dwordx4 v[76:79], v101, s[56:59], s17 offen sc1
L_l_sk2:
    s_mov_b64 exec, -1
    s_add_u32 s63, s63, 1
    s_cmp_ge_u32 s63, 4194304
    s_cbranch_scc1 L_l_got1
    s_waitcnt vmcnt(0)
    v_mfma_f32_16x16x32_bf16 v[80:83], v[88:91], v[32:35], 0
    v_max3_u32 v11, v32, v33, 0
    v_max3_u32 v11, v11, v34, v35
    v_mfma_f32_16x16x32_bf16 v[80:83], v[92:95], v[36:39], v[80:83]
    v_max3_u32 v11, v36, v37, v11
    v_max3_u32 v11, v11, v38, v39
    v_mfma_f32_16x16x32_bf16 v[84:87], v[88:91], v[40:43], 0
    v_max3_u32 v11, v40, v41, v11
    v_max3_u32 v11, v11, v42, v43
    v_mfma_f32_16x16x32_bf16 v[84:87], v[92:95], v[44:47], v[84:87]
    v_max3_u32 v11, v44, v45, v11
    v_max3_u32 v11, v11, v46, v47
    v_cmp_eq_u32 s[74:75], -1, v11
    v_mfma_f32_16x16x32_bf16 v[80:83], v[88:91], v[48:51], v[80:83]
    v_max3_u32 v11, v48, v49, 0
    v_max3_u32 v11, v11, v50, v51
    v_mfma_f32_16x16x32_bf16 v[80:83], v[92:95], v[52:55], v[80:83]
    v_max3_u32 v11, v52, v53, v11
    v_max3_u32 v11, v11, v54, v55
    v_mfma_f32_16x16x32_bf16 v[84:87], v[88:91], v[56:59], v[84:87]
    v_max3_u32 v11, v56, v57, v11
    v_max3_u32 v11, v11, v58, v59
    v_mfma_f32_16x16x32_bf16 v[84:87], v[92:95], v[60:63], v[84:87]
    v_max3_u32 v11, v60, v61, v11
    v_max3_u32 v11, v11, v62, v63
    v_cmp_eq_u32 s[76:77], -1, v11
    v_mfma_f32_16x16x32_bf16 v[80:83], v[88:91], v[64:67], v[80:83]
    v_max3_u32 v11, v64, v65, 0
    v_max3_u32 v11, v11, v66, v67
    v_mfma_f32_16x16x32_bf16 v[80:83], v[92:95], v[68:71], v[80:83]
    v_max3_u32 v11, v68, v69, v11
    v_max3_u32 v11, v11, v70, v71
    v_mfma_f32_16x16x32_bf16 v[84:87], v[88:91], v[72:75], v[84:87]
    v_max3_u32 v11, v72, v73, v11
    v_max3_u32 v11, v11, v74, v75
    v_mfma_f32_16x16x32_bf16 v[84:87], v[92:95], v[76:79], v[84:87]
    v_max3_u32 v11, v76, v77, v11
    v_max3_u32 v11, v11, v78, v79
    v_cmp_eq_u32 s[78:79], -1, v11
    s_or_b64 vcc, s[74:75], s[76:77]
    s_or_b64 vcc, vcc, s[78:79]
    s_cbranch_scc1 L_l_again
    s_branch L_l_got1
L_c_fail0:
    buffer_load_dwordx4 v[192:195], v2, s[52:55], s70 offen offset:0 sc1
    buffer_load_dwordx4 v[196:199], v2, s[52:55], s70 offen offset:1280 sc1
    buffer_load_dwordx4 v[200:203], v2, s[52:55], s70 offen offset:2560 sc1
    buffer_load_dwordx4 v[204:207], v2, s[52:55], s70 offen offset:3840 sc1
    buffer_load_dwordx4 v[208:211], v3, s[52:55], s70 offen offset:1024 sc1
    s_waitcnt vmcnt(0)
    v_max3_u32 v14, v208, v192, v196
    v_max3_u32 v14, v14, v200, v204
    v_cmp_eq_u32_e64 vcc, -1, v14
    s_add_u32 s63, s63, 1
    s_cmp_ge_u32 s63, 4194304
    s_cbranch_scc1 L_c_ok0
    s_cbranch_vccnz L_c_fail0
    buffer_load_dwordx4 v[212:215], v2, s[52:55], s73 offen offset:0 sc1
    buffer_load_dwordx4 v[216:219], v2, s[52:55], s73 offen offset:1280 sc1
    buffer_load_dwordx4 v[220:223], v2, s[52:55], s73 offen offset:2560 sc1
    buffer_load_dwordx4 v[224:227], v2, s[52:55], s73 offen offset:3840 sc1
    buffer_load_dwordx4 v[228:231], v3, s[52:55], s73 offen offset:1024 sc1
    s_branch L_c_ok0
    s_nop 0
L_c_fail1:
    buffer_load_dwordx4 v[212:215], v2, s[52:55], s73 offen offset:0 sc1
    buffer_load_dwordx4 v[216:219], v2, s[52:55], s73 offen offset:1280 sc1
    buffer_load_dwordx4 v[220:223], v2, s[52:55], s73 offen offset:2560 sc1
    buffer_load_dwordx4 v[224:227], v2, s[52:55], s73 offen offset:3840 sc1
    buffer_load_dwordx4 v[228:231], v3, s[52:55], s73 offen offset:1024 sc1
    s_waitcnt vmcnt(0)
    v_max3_u32 v14, v228, v212, v216
    v_max3_u32 v14, v14, v220, v224
    v_cmp_eq_u32_e64 vcc, -1, v14
    s_add_u32 s63, s63, 1
    s_cmp_ge_u32 s63, 4194304
    s_cbranch_scc1 L_c_ok1
    s_cbranch_vccnz L_c_fail1
    buffer_load_dwordx4 v[232:235], v2, s[52:55], s74 offen offset:0 sc1
    buffer_load_dwordx4 v[236:239], v2, s[52:55], s74 offen offset:1280 sc1
    buffer_load_dwordx4 v[240:243], v2, s[52:55], s74 offen offset:2560 sc1
    buffer_load_dwordx4 v[244:247], v2, s[52:55], s74 offen offset:3840 sc1
    buffer_load_dwordx4 v[248:251], v3, s[52:55], s74 offen offset:1024 sc1
    s_branch L_c_ok1
    s_nop 0
L_c_fail2:
    buffer_load_dwordx4 v[232:235], v2, s[52:55], s74 offen offset:0 sc1
    buffer_load_dwordx4 v[236:239], v2, s[52:55], s74 offen offset:1280 sc1
    buffer_load_dwordx4 v[240:243], v2, s[52:55], s74 offen offset:2560 sc1
    buffer_load_dwordx4 v[244:247], v2, s[52:55], s74 offen offset:3840 sc1
    buffer_load_dwordx4 v[248:251], v3, s[52:55], s74 offen offset:1024 sc1
    s_waitcnt vmcnt(0)
    v_max3_u32 v14, v248, v232, v236
    v_max3_u32 v14, v14, v240, v244
    v_cmp_eq_u32_e64 vcc, -1, v14
    s_add_u32 s63, s63, 1
    s_cmp_ge_u32 s63, 4194304
    s_cbranch_scc1 L_c_ok2
    s_cbranch_vccnz L_c_fail2
    buffer_load_dwordx4 v[192:195], v2, s[52:55], s75 offen offset:0 sc1
    buffer_load_dwordx4 v[196:199], v2, s[52:55], s75 offen offset:1280 sc1
    buffer_load_dwordx4 v[200:203], v2, s[52:55], s75 offen offset:2560 sc1
    buffer_load_dwordx4 v[204:207], v2, s[52:55], s75 offen offset:3840 sc1
    buffer_load_dwordx4 v[208:211], v3, s[52:55], s75 offen offset:1024 sc1
    s_branch L_c_ok2
    s_nop 0
L_c_fail3:
    buffer_load_dwordx4 v[192:195], v2, s[52:55], s75 offen offset:0 sc1
    buffer_load_dwordx4 v[196:199], v2, s[52:55], s75 offen offset:1280 sc1
    buffer_load_dwordx4 v[200:203], v2, s[52:55], s75 offen offset:2560 sc1
    buffer_load_dwordx4 v[204:207], v2, s[52:55], s75 offen offset:3840 sc1
    buffer_load_dwordx4 v[208:211], v3, s[52:55], s75 offen offset:1024 sc1
    s_waitcnt vmcnt(0)
    v_max3_u32 v14, v208, v192, v196
    v_max3_u32 v14, v14, v200, v204
    v_cmp_eq_u32_e64 vcc, -1, v14
    s_add_u32 s63, s63, 1
    s_cmp_ge_u32 s63, 4194304
    s_cbranch_scc1 L_c_ok3
    s_cbranch_vccnz L_c_fail3
    buffer_load_dwordx4 v[212:215], v2, s[52:55], s76 offen offset:0 sc1
    buffer_load_dwordx4 v[216:219], v2, s[52:55], s76 offen offset:1280 sc1
    buffer_load_dwordx4 v[220:223], v2, s[52:55], s76 offen offset:2560 sc1
    buffer_load_dwordx4 v[224:227], v2, s[52:55], s76 offen offset:3840 sc1
    buffer_load_dwordx4 v[228:231], v3, s[52:55], s76 offen offset:1024 sc1
    s_branch L_c_ok3
    s_nop 0
L_c_fail4:
    buffer_load_dwordx4 v[212:215], v2, s[52:55], s76 offen offset:0 sc1
    buffer_load_dwordx4 v[216:219], v2, s[52:55], s76 offen offset:1280 sc1
    buffer_load_dwordx4 v[220:223], v2, s[52:55], s76 offen offset:2560 sc1
    buffer_load_dwordx4 v[224:227], v2, s[52:55], s76 offen offset:3840 sc1
    buffer_load_dwordx4 v[228:231], v3, s[52:55], s76 offen offset:1024 sc1
    s_waitcnt vmcnt(0)
    v_max3_u32 v14, v228, v212, v216
    v_max3_u32 v14, v14, v220, v224
    v_cmp_eq_u32_e64 vcc, -1, v14
    s_add_u32 s63, s63, 1
    s_cmp_ge_u32 s63, 4194304
    s_cbranch_scc1 L_c_ok4
    s_cbranch_vccnz L_c_fail4
    buffer_load_dwordx4 v[232:235], v2, s[52:55], s77 offen offset:0 sc1
    buffer_load_dwordx4 v[236:239], v2, s[52:55], s77 offen offset:1280 sc1
    buffer_load_dwordx4 v[240:243], v2, s[52:55], s77 offen offset:2560 sc1
    buffer_load_dwordx4 v[244:247], v2, s[52:55], s77 offen offset:3840 sc1
    buffer_load_dwordx4 v[248:251], v3, s[52:55], s77 offen offset:1024 sc1
    s_branch L_c_ok4
    s_nop 0
L_c_fail5:
    buffer_load_dwordx4 v[232:235], v2, s[52:55], s77 offen offset:0 sc1
    buffer_load_dwordx4 v[236:239], v2, s[52:55], s77 offen offset:1280 sc1
    buffer_load_dwordx4 v[240:243], v2, s[52:55], s77 offen offset:2560 sc1
    buffer_load_dwordx4 v[244:247], v2, s[52:55], s77 offen offset:3840 sc1
    buffer_load_dwordx4 v[248:251], v3, s[52:55], s77 offen offset:1024 sc1
    s_waitcnt vmcnt(0)
    v_max3_u32 v14, v248, v232, v236
    v_max3_u32 v14, v14, v240, v244
    v_cmp_eq_u32_e64 vcc, -1, v14
    s_add_u32 s63, s63, 1
    s_cmp_ge_u32 s63, 4194304
    s_cbranch_scc1 L_c_ok5
    s_cbranch_vccnz L_c_fail5
    buffer_load_dwordx4 v[192:195], v2, s[52:55], s78 offen offset:0 sc1
    buffer_load_dwordx4 v[196:199], v2, s[52:55], s78 offen offset:1280 sc1
    buffer_load_dwordx4 v[200:203], v2, s[52:55], s78 offen offset:2560 sc1
    buffer_load_dwordx4 v[204:207], v2, s[52:55], s78 offen offset:3840 sc1
    buffer_load_dwordx4 v[208:211], v3, s[52:55], s78 offen offset:1024 sc1
    s_branch L_c_ok5
    s_nop 0
L_c_fail6:
    buffer_load_dwordx4 v[192:195], v2, s[52:55], s78 offen offset:0 sc1
    buffer_load_dwordx4 v[196:199], v2, s[52:55], s78 offen offset:1280 sc1
    buffer_load_dwordx4 v[200:203], v2, s[52:55], s78 offen offset:2560 sc1
    buffer_load_dwordx4 v[204:207], v2, s[52:55], s78 offen offset:3840 sc1
    buffer_load_dwordx4 v[208:211], v3, s[52:55], s78 offen offset:1024 sc1
    s_waitcnt vmcnt(0)
    v_max3_u32 v14, v208, v192, v196
    v_max3_u32 v14, v14, v200, v204
    v_cmp_eq_u32_e64 vcc, -1, v14
    s_add_u32 s63, s63, 1
    s_cmp_ge_u32 s63, 4194304
    s_cbranch_scc1 L_c_ok6
    s_cbranch_vccnz L_c_fail6
    buffer_load_dwordx4 v[212:215], v2, s[52:55], s79 offen offset:0 sc1
    buffer_load_dwordx4 v[216:219], v2, s[52:55], s79 offen offset:1280 sc1
    buffer_load_dwordx4 v[220:223], v2, s[52:55], s79 offen offset:2560 sc1
    buffer_load_dwordx4 v[224:227], v2, s[52:55], s79 offen offset:3840 sc1
    buffer_load_dwordx4 v[228:231], v3, s[52:55], s79 offen offset:1024 sc1
    s_branch L_c_ok6
    s_nop 0
L_c_fail7:
    buffer_load_dwordx4 v[212:215], v2, s[52:55], s79 offen offset:0 sc1
    buffer_load_dwordx4 v[216:219], v2, s[52:55], s79 offen offset:1280 sc1
    buffer_load_dwordx4 v[220:223], v2, s[52:55], s79 offen offset:2560 sc1
    buffer_load_dwordx4 v[224:227], v2, s[52:55], s79 offen offset:3840 sc1
    buffer_load_dwordx4 v[228:231], v3, s[52:55], s79 offen offset:1024 sc1
    s_waitcnt vmcnt(0)
    v_max3_u32 v14, v228, v212, v216
    v_max3_u32 v14, v14, v220, v224
    v_cmp_eq_u32_e64 vcc, -1, v14
    s_add_u32 s63, s63, 1
    s_cmp_ge_u32 s63, 4194304
    s_cbranch_scc1 L_c_ok7
    s_cbranch_vccnz L_c_fail7
    s_branch L_c_ok7
L_c_scan:
    s_waitcnt lgkmcnt(0)
    s_mov_b32 s39, s70
    v_mov_b32 v14, 0
L_c_scan1:
    buffer_load_dwordx4 v[192:195], v2, s[52:55], s39 offen offset:0 sc1
    buffer_load_dwordx4 v[196:199], v2, s[52:55], s39 offen offset:1280 sc1
    buffer_load_dwordx4 v[200:203], v2, s[52:55], s39 offen offset:2560 sc1
    buffer_load_dwordx4 v[204:207], v2, s[52:55], s39 offen offset:3840 sc1
    buffer_load_dwordx4 v[208:211], v3, s[52:55], s39 offen offset:1024 sc1
    s_waitcnt vmcnt(4)
    v_max3_u32 v14, v14, v192, v193
    v_max3_u32 v14, v14, v194, v195
    s_waitcnt vmcnt(3)
    v_max3_u32 v14, v14, v196, v197
    v_max3_u32 v14, v14, v198, v199
    s_waitcnt vmcnt(2)
    v_max3_u32 v14, v14, v200, v201
    v_max3_u32 v14, v14, v202, v203
    s_waitcnt vmcnt(1)
    v_max3_u32 v14, v14, v204, v205
    v_max3_u32 v14, v14, v206, v207
    s_waitcnt vmcnt(0)
    v_max3_u32 v14, v14, v208, v209
    v_max3_u32 v14, v14, v210, v211
    s_add_u32 s39, s39, 16384
    s_cmp_le_u32 s39, s79
    s_cbranch_scc1 L_c_scan1
    v_cmp_eq_u32 vcc, -1, v14
    s_mov_b64 s[44:45], 0
    s_add_u32 s63, s63, 1
    s_cmp_ge_u32 s63, 4194304
    s_cbranch_scc1 L_c_g2
    s_cbranch_vccnz L_c_scan
    s_branch L_c_g2
L_B:
    s_sub_u32 s5, s5, s100
    s_and_b32 s7, s4, 3
    s_mul_i32 s6, s7, 12
    s_sub_u32 s6, s6, 4
    s_max_i32 s6, s6, 0
    s_lshr_b32 s7, s4, 2
    s_mul_i32 s7, s7, 40
    s_add_u32 s7, s7, s6
    s_add_u32 s6, s7, s5
    s_lshl_b32 s40, s6, 3
    s_add_u32 s40, s40, s3
    s_mul_i32 s41, s40, 384
    v_mul_u32_u24_e64 v14, 6, v1
    v_and_b32 v14, -4, v14
    v_add_u32 v14, s41, v14
    s_lshr_b32 s42, s40, 1
    s_lshl_b32 s42, s42, 2
    s_add_u32 s43, s42, 2620160
    s_cmp_lg_u32 s101, 0
    s_cselect_b32 s67, 27, 46
    s_cselect_b32 s61, 24, 36
    s_cselect_b32 s37, 0, 960
    s_bfm_b64 s[68:69], s67, 0
    s_bfm_b64 s[70:71], s61, 0
    s_mul_i32 s36, s5, s67
    s_mul_i32 s36, s36, 3
    s_add_u32 s36, s36, s37
    v_add_u32_e64 v160, s36, v1
    v_mul_u32_u24 v160, 1280, v160
    s_mul_i32 s67, s67, 1280
    s_mul_i32 s61, s61, 1280
    s_mul_hi_u32 s61, s61, 0x55555556
    v_mul_u32_u24 v161, 21846, v1
    v_lshrrev_b32_e64 v161, 16, v161
    v_mul_u32_u24 v161, 896, v161
    s_lshr_b32 s37, s4, 1
    s_mul_i32 s37, s37, 320
    s_and_b32 s37, s37, 0xff80
    s_mul_i32 s36, s5, s61
    s_lshl1_add_u32 s37, s36, s37
    v_lshl_add_u32 v162, v1, 7, s37
    v_add_u32 v162, v161, v162
    s_movk_i32 s38, 128
    s_lshr_b32 s99, s4, 1
    s_mul_i32 s99, s99, 12
    s_add_u32 s99, s99, s5
    s_mul_i32 s99, s99, 15360
    s_add_u32 s99, s99, 4210688
    s_mul_i32 s98, s101, s3
    v_lshl_add_u32 v163, v1, 4, s99
    v_mov_b32 v164, -1
    v_mov_b32_e64 v165, -1
    v_pk_mov_b32 v[166:167], v[164:165], v[164:165]
    s_waitcnt lgkmcnt(0)
    s_nop 0
    global_load_dwordx2 v[16:17], v14, s[18:19]
    global_load_dwordx2 v[18:19], v14, s[20:21]
    global_load_dwordx2 v[20:21], v14, s[22:23]
    global_load_dwordx2 v[22:23], v14, s[24:25]
    s_load_dword s44, s[26:27], s42
    s_load_dword s45, s[28:29], s42
    s_load_dword s46, s[16:17], s43
    s_cmp_lg_u32 s98, 7
    s_cbranch_scc1 L_b_noclr
    s_mov_b32 s57, 4206592
    s_load_dword s57, s[34:35], s57
    global_store_dwordx4 v163, v[164:167], s[34:35] offset:0 sc1
    global_store_dwordx4 v163, v[164:167], s[34:35] offset:1024 sc1
    global_store_dwordx4 v163, v[164:167], s[34:35] offset:2048 sc1
    global_store_dwordx4 v163, v[164:167], s[34:35] offset:3072 sc1
    v_add_u32 v163, 4096, v163
    global_store_dwordx4 v163, v[164:167], s[34:35] offset:0 sc1
    global_store_dwordx4 v163, v[164:167], s[34:35] offset:1024 sc1
    global_store_dwordx4 v163, v[164:167], s[34:35] offset:2048 sc1
    global_store_dwordx4 v163, v[164:167], s[34:35] offset:3072 sc1
    v_add_u32 v163, 4096, v163
    global_store_dwordx4 v163, v[164:167], s[34:35] offset:0 sc1
    global_store_dwordx4 v163, v[164:167], s[34:35] offset:1024 sc1
    global_store_dwordx4 v163, v[164:167], s[34:35] offset:2048 sc1
    global_store_dwordx4 v163, v[164:167], s[34:35] offset:3072 sc1
    v_add_u32 v163, 4096, v163
    global_store_dwordx4 v163, v[164:167], s[34:35] offset:0 sc1
    global_store_dwordx4 v163, v[164:167], s[34:35] offset:1024 sc1
    global_store_dwordx4 v163, v[164:167], s[34:35] offset:2048 sc1
L_b_noclr:
    s_mov_b32 s72, s8
    s_mov_b32 s73, s9
    s_mov_b32 s74, 2621440
    s_mov_b32 s75, 0x20000
    s_mov_b32 s76, s10
    s_mov_b32 s77, s11
    s_mov_b32 s78, 2457600
    s_mov_b32 s79, 0x20000
    s_barrier
    s_cmp_lg_u32 s3, 0
    s_cbranch_scc1 L_b_nopf
    s_add_u32 s37, s38, 512
L_b_pf0:
    s_mov_b64 exec, s[68:69]
    s_add_u32 s36, s38, s67
    buffer_load_dword v31, v160, s[72:75], s38 offen
    buffer_load_dword v31, v160, s[72:75], s36 offen
    s_add_u32 s36, s36, s67
    s_mul_i32 s39, s38, 1920
    buffer_load_dword v31, v160, s[72:75], s36 offen
    s_mov_b64 exec, s[70:71]
    s_add_u32 s36, s39, s61
    buffer_load_dword v31, v162, s[76:79], s39 offen
    buffer_load_dword v31, v162, s[76:79], s36 offen
    s_addk_i32 s38, 128
    s_cmp_lt_u32 s38, s37
    s_cbranch_scc1 L_b_pf0
    s_mov_b64 exec, -1
    s_branch L_b_nopf
    s_nop 0
L_b_nopf:
    v_mul_u32_u24 v15, 2560, v0
    s_mov_b32 s48, s16
    s_mov_b32 s49, s17
    s_mov_b32 s50, 2621440
    s_mov_b32 s51, 0x20000
    s_lshl_b32 s41, s6, 4
    v_subrev_u32 v14, 1280, v15
    s_mov_b32 s47, s41
    v_and_b32_e64 v32, 15, v1
    v_lshrrev_b32 v33, 4, v1
    s_lshl_b32 s42, s3, 2
    s_lshr_b32 s43, 0x17795353, s42
    s_and_b32 s43, s43, 15
    s_bfm_b32 s43, s43, 0
    s_lshr_b32 s42, 0x1a1b830, s42
    s_and_b32 s42, s42, 15
    s_lshl_b32 s43, s43, s42
    v_lshlrev_b32 v34, v32, s43
    v_lshlrev_b32 v35, 3, v33
    v_lshrrev_b32 v34, v35, v34
    s_movk_i32 s42, 0x3f80
    s_cmp_eq_u32 s3, 6
    s_cselect_b32 s42, 0xffff, s42
    s_mov_b32 s43, 0x10001
    v_bfe_u32 v36, v34, 0, 2
    v_lshl_or_b32 v36, v36, 15, v36
    v_and_b32 v36, s43, v36
    v_mul_u32_u24 v36, s42, v36
    v_bfe_u32 v37, v34, 2, 2
    v_lshl_or_b32 v37, v37, 15, v37
    v_and_b32 v37, s43, v37
    v_mul_u32_u24 v37, s42, v37
    v_bfe_u32 v38, v34, 4, 2
    v_lshl_or_b32 v38, v38, 15, v38
    v_and_b32 v38, s43, v38
    v_mul_u32_u24 v38, s42, v38
    v_bfe_u32 v39, v34, 6, 2
    v_lshl_or_b32 v39, v39, 15, v39
    v_and_b32_e64 v39, s43, v39
    v_mul_u32_u24 v39, s42, v39
    v_lshlrev_b32 v35, 4, v0
    v_add_u32 v35, 155680, v35
    s_cmp_eq_u32 s3, 7
    s_cbranch_scc1 L_b_noband
    ds_write_b128 v35, v[36:39]
L_b_noband:
    s_lshl_b32 s52, s3, 8
    s_nop 0
    s_add_u32 s53, s52, 57344
    v_lshl_add_u32 v37, v33, 4, s52
    v_mov_b32 v39, 2080
    v_mad_u32_u24 v35, v32, v39, v37
    v_add_u32 v37, 66560, v37
    v_lshlrev_b32_e64 v36, 2, v32
    s_mov_b32 s54, 0x76543210
    s_mov_b32 s55, 0xfebbba88
    v_lshrrev_b64 v[40:41], v36, s[54:55]
    v_and_b32_e64 v40, 15, v40
    v_mad_u32_u24 v34, v40, v39, v37
    s_mov_b32 s54, 0x444ba987
    s_mov_b32 s55, 0x4444fedc
    v_lshrrev_b64 v[40:41], v36, s[54:55]
    v_and_b32_e64 v40, 15, v40
    v_mad_u32_u24 v132, v40, v39, v37
    s_mov_b32 m0, s53
    v_mov_b32 v36, 0x3c00
    v_mov_b32 v38, 0
    ds_write_addtid_b32 v36 offset:9216
    ds_write_addtid_b32 v38 offset:36256
    s_mul_i32 s42, s3, 4640
    s_add_u32 s42, s42, 118560
    v_mov_b32 v36, 0
    v_mov_b32 v37, 0
    v_lshl_add_u32 v38, v1, 3, s42
    ds_write_b64 v38, v[36:37]
    v_cmp_ne_u32_e64 vcc, 0, v1
    v_mov_b32 v39, 4096
    s_nop 0
    v_cndmask_b32 v39, 0, v39, vcc
    v_add_u32_e64 v38, v38, v39
    s_waitcnt lgkmcnt(0)
    s_bitcmp1_b32 s40, 0
    s_cselect_b32 s42, 16, 0
    s_lshr_b32 s46, s46, s42
    s_and_b32 s46, s46, 0xffff
    s_lshr_b32 s44, s44, s42
    s_lshl_b32 s44, s44, 16
    s_lshr_b32 s45, s45, s42
    s_lshl_b32 s45, s45, 16
    v_writelane_b32 v36, s46, 1
    s_mov_b64 exec, 15
    ds_write_b64 v38, v[36:37] offset:512
    s_mov_b64 exec, -1
    s_mov_b32 s58, 0x3fb8aa3b
    s_mov_b32 s59, 0x3e22f983
    v_mov_b32 v36, s44
    v_mul_f32_e64 v37, s58, v36
    v_fma_f32 v38, v36, s58, -v37
    v_fmac_f32 v38, 0x32a57060, v36
    v_exp_f32_e64 v37, v37
    v_mul_f32 v38, 0x3f317218, v38
    v_fma_f32 v37, v37, v38, v37
    v_cvt_pk_bf16_f32 v37, v37, v37
    v_lshlrev_b32_e64 v37, 16, v37
    v_add_f32 v38, v37, v37
    v_readfirstlane_b32 s54, v37
    v_readfirstlane_b32 s56, v38
    v_and_b32 v36, 1, v1
    v_lshlrev_b32 v36, 4, v36
    s_waitcnt vmcnt(20) lgkmcnt(0)
    s_cmp_eq_u32 s3, 0
    s_cbranch_scc1 L_b_w0
    s_waitcnt vmcnt(0)
L_b_w0:
    s_cmp_lg_u32 s98, 7
    s_cbranch_scc1 L_b_w1
    s_mov_b32 s36, s99
    s_mov_b32 s37, 0
    s_mov_b32 s39, 0
    s_load_dword s39, s[34:35], s36 glc
L_b_r0:
    s_add_u32 s37, s37, 1
    s_lshr_b32 s57, s37, 12
    s_or_b32 s57, s57, s39
    s_cbranch_scc0 L_b_r0
    s_waitcnt lgkmcnt(0)
    s_add_u32 s36, s36, 8192
    s_mov_b32 s38, 0
    s_mov_b32 s39, 0
    s_load_dword s39, s[34:35], s36 glc
L_b_r1:
    s_add_u32 s38, s38, 1
    s_lshr_b32 s57, s38, 12
    s_or_b32 s57, s57, s39
    s_cbranch_scc0 L_b_r1
    s_waitcnt lgkmcnt(0)
    s_sub_u32 s37, s37, s38
    s_max_i32 s37, s37, -8
    s_min_i32 s37, s37, 8
    s_lshr_b32 s36, s36, 11
    s_xor_b32 s36, s36, s4
    s_bitcmp1_b32 s36, 2
    s_cselect_b32 s36, 1, -1
    s_mul_i32 s36, s36, s37
    s_lshl_b32 s36, s36, 16
    s_add_u32 s36, s36, 1
    v_mov_b32_e64 v162, 0
    v_mov_b32 v163, s36
    s_mov_b64 exec, 1
    global_atomic_add v162, v163, s[32:33]
    s_mov_b64 exec, -1
L_b_w1:
    v_alignbit_b32 v16, v17, v16, v36
    v_lshrrev_b32 v17, v36, v17
    v_lshlrev_b32_e64 v2, 16, v16
    v_and_b32 v6, 0xffff0000, v16
    v_lshlrev_b32_e64 v10, 16, v17
    v_alignbit_b32 v18, v19, v18, v36
    v_lshrrev_b32 v19, v36, v19
    v_lshlrev_b32 v3, 16, v18
    v_and_b32 v7, 0xffff0000, v18
    v_lshlrev_b32_e64 v11, 16, v19
    v_alignbit_b32 v20, v21, v20, v36
    v_lshrrev_b32 v21, v36, v21
    v_lshlrev_b32 v4, 16, v20
    v_and_b32 v8, 0xffff0000, v20
    v_lshlrev_b32_e64 v12, 16, v21
    v_alignbit_b32 v22, v23, v22, v36
    v_lshrrev_b32 v23, v36, v23
    v_lshlrev_b32 v5, 16, v22
    v_and_b32 v9, 0xffff0000, v22
    v_lshlrev_b32_e64 v13, 16, v23
    v_max3_f32 v36, abs(v4), abs(v5), abs(v8)
    v_max3_f32 v36, v36, abs(v9), abs(v12)
    v_max_f32 v36, v36, abs(v13)
    s_nop 1
    v_max_u32_dpp v36, v36, v36 row_shr:1 row_mask:0xf bank_mask:0xf
    s_nop 1
    v_max_u32_dpp v36, v36, v36 row_shr:2 row_mask:0xf bank_mask:0xf
    s_nop 1
    v_max_u32_dpp v36, v36, v36 row_shr:4 row_mask:0xf bank_mask:0xf
    s_nop 1
    v_max_u32_dpp v36, v36, v36 row_shr:8 row_mask:0xf bank_mask:0xf
    s_nop 1
    v_max_u32_dpp v36, v36, v36 row_bcast:15 row_mask:0xf bank_mask:0xf
    s_nop 1
    v_max_u32_dpp v36, v36, v36 row_bcast:31 row_mask:0xf bank_mask:0xf
    s_nop 0
    v_readlane_b32 s42, v36, 63
    s_nop 0
    s_lshr_b32 s42, s42, 23
    s_max_u32 s42, s42, 1
    s_min_u32 s42, s42, 253
    s_lshl_b32 s42, s42, 23
    s_sub_u32 s66, 2130706432, s42
    v_mov_b32 v134, s56
    v_mul_f32_e64 v134, s42, v134
    s_mov_b32 s56, s66
    s_setprio 3
    v_mul_f32 v2, s58, v2
    v_mul_f32 v99, s54, v3
    v_exp_f32 v2, v2
    v_mul_f32 v99, s59, v99
    v_cvt_pk_bf16_f32 v2, v2, v2
    v_lshlrev_b32_e64 v2, 16, v2
    v_fract_f32 v100, v99
    v_mul_f32 v98, s54, v2
    v_mul_f32 v101, 0x42800000, v99
    v_mul_f32 v98, s58, v98
    v_fract_f32 v101, v101
    v_mul_f32 v103, 0x42800000, v98
    v_cos_f32 v56, v100
    v_sin_f32 v57, v100
    v_exp_f32 v102, -v98
    v_cos_f32 v66, v101
    v_sin_f32 v67, v101
    v_exp_f32 v104, -v103
    v_pk_mul_f32 v[56:57], v[56:57], v[102:103] op_sel_hi:[1,0]
    v_pk_mul_f32 v[82:83], v[4:5], s[56:57] op_sel_hi:[1,0]
    v_pk_mul_f32 v[66:67], v[66:67], v[104:105] op_sel_hi:[1,0]
    s_mov_b32 m0, s53
    s_nop 0
    v_cvt_pk_f16_f32 v136, v56, v57
    v_pk_mul_f32 v[58:59], v[56:57], v[56:57] op_sel:[0,0] op_sel_hi:[0,1]
    v_pk_fma_f32 v[58:59], v[56:57], v[56:57], v[58:59] op_sel:[1,1,0] op_sel_hi:[1,0,1] neg_lo:[0,1,0]
    v_cvt_pk_f16_f32 v137, v58, v59
    v_pk_mul_f32 v[60:61], v[58:59], v[58:59] op_sel:[0,0] op_sel_hi:[0,1]
    v_pk_fma_f32 v[60:61], v[58:59], v[58:59], v[60:61] op_sel:[1,1,0] op_sel_hi:[1,0,1] neg_lo:[0,1,0]
    v_cvt_pk_f16_f32 v138, v60, v61
    v_pk_mul_f32 v[64:65], v[60:61], v[60:61] op_sel:[0,0] op_sel_hi:[0,1]
    v_pk_fma_f32 v[64:65], v[60:61], v[60:61], v[64:65] op_sel:[1,1,0] op_sel_hi:[1,0,1] neg_lo:[0,1,0]
    v_cvt_pk_f16_f32 v140, v64, v65
    v_pk_mul_f32 v[62:63], v[60:61], v[58:59] op_sel:[0,0] op_sel_hi:[0,1]
    v_pk_fma_f32 v[62:63], v[60:61], v[58:59], v[62:63] op_sel:[1,1,0] op_sel_hi:[1,0,1] neg_lo:[0,1,0]
    v_cvt_pk_f16_f32 v139, v62, v63
    ds_write_addtid_b32 v136 offset:11296
    ds_write_addtid_b32 v137 offset:13376
    ds_write_addtid_b32 v138 offset:17536
    ds_write_addtid_b32 v139 offset:21696
    v_pk_mul_f32 v[68:69], v[66:67], v[66:67] op_sel:[0,0] op_sel_hi:[0,1]
    v_pk_fma_f32 v[68:69], v[66:67], v[66:67], v[68:69] op_sel:[1,1,0] op_sel_hi:[1,0,1] neg_lo:[0,1,0]
    v_pk_mul_f32 v[72:73], v[68:69], v[68:69] op_sel:[0,0] op_sel_hi:[0,1]
    v_pk_fma_f32 v[72:73], v[68:69], v[68:69], v[72:73] op_sel:[1,1,0] op_sel_hi:[1,0,1] neg_lo:[0,1,0]
    v_cvt_pk_f16_f32 v144, v72, v73
    v_pk_mul_f32 v[74:75], v[72:73], v[72:73] op_sel:[0,0] op_sel_hi:[0,1]
    v_pk_fma_f32 v[74:75], v[72:73], v[72:73], v[74:75] op_sel:[1,1,0] op_sel_hi:[1,0,1] neg_lo:[0,1,0]
    v_cvt_pk_f16_f32 v145, v74, v75
    v_pk_mul_f32 v[76:77], v[74:75], v[72:73] op_sel:[0,0] op_sel_hi:[0,1]
    v_pk_fma_f32 v[76:77], v[74:75], v[72:73], v[76:77] op_sel:[1,1,0] op_sel_hi:[1,0,1] neg_lo:[0,1,0]
    v_cvt_pk_f16_f32 v146, v76, v77
    v_pk_mul_f32 v[78:79], v[74:75], v[74:75] op_sel:[0,0] op_sel_hi:[0,1]
    v_pk_fma_f32 v[78:79], v[74:75], v[74:75], v[78:79] op_sel:[1,1,0] op_sel_hi:[1,0,1] neg_lo:[0,1,0]
    v_cvt_pk_f16_f32 v147, v78, v79
    ds_write_addtid_b32 v144 offset:25856
    ds_write_addtid_b32 v145 offset:42496
    ds_write_addtid_b32 v146 offset:52896
    ds_write_addtid_b32 v147 offset:50816
    v_pk_mul_f32 v[80:81], v[78:79], v[64:65] op_sel:[0,0] op_sel_hi:[0,1]
    v_pk_fma_f32 v[80:81], v[78:79], v[64:65], v[80:81] op_sel:[1,1,0] op_sel_hi:[1,0,1] neg_lo:[0,1,0]
    v_cvt_pk_f16_f32 v148, v80, v81
    v_pk_mul_f32 v[70:71], v[68:69], v[66:67] op_sel:[0,0] op_sel_hi:[0,1]
    v_pk_fma_f32 v[70:71], v[68:69], v[66:67], v[70:71] op_sel:[1,1,0] op_sel_hi:[1,0,1] neg_lo:[0,1,0]
    v_pk_mul_f16 v114, v137, v136 op_sel:[0,0] op_sel_hi:[0,1]
    v_pk_fma_f16 v114, v137, v136, v114 op_sel:[1,1,0] op_sel_hi:[1,0,1] neg_lo:[0,1,0]
    v_pk_mul_f16 v115, v138, v136 op_sel:[0,0] op_sel_hi:[0,1]
    v_pk_fma_f16 v115, v138, v136, v115 op_sel:[1,1,0] op_sel_hi:[1,0,1] neg_lo:[0,1,0]
    v_pk_mul_f16 v116, v139, v136 op_sel:[0,0] op_sel_hi:[0,1]
    v_pk_fma_f16 v116, v139, v136, v116 op_sel:[1,1,0] op_sel_hi:[1,0,1] neg_lo:[0,1,0]
    ds_write_addtid_b32 v148 offset:46656
    ds_write_addtid_b32 v114 offset:15456
    ds_write_addtid_b32 v115 offset:19616
    ds_write_addtid_b32 v116 offset:23776
    v_pk_mul_f16 v117, v144, v137 op_sel:[0,0] op_sel_hi:[0,1]
    v_pk_fma_f16 v117, v144, v137, v117 op_sel:[1,1,0] op_sel_hi:[1,0,1] neg_lo:[0,1,0]
    v_pk_mul_f16 v118, v144, v138 op_sel:[0,0] op_sel_hi:[0,1]
    v_pk_fma_f16 v118, v144, v138, v118 op_sel:[1,1,0] op_sel_hi:[1,0,1] neg_lo:[0,1,0]
    v_pk_mul_f16 v119, v144, v139 op_sel:[0,0] op_sel_hi:[0,1]
    v_pk_fma_f16 v119, v144, v139, v119 op_sel:[1,1,0] op_sel_hi:[1,0,1] neg_lo:[0,1,0]
    v_pk_mul_f16 v120, v144, v140 op_sel:[0,0] op_sel_hi:[0,1]
    v_pk_fma_f16 v120, v144, v140, v120 op_sel:[1,1,0] op_sel_hi:[1,0,1] neg_lo:[0,1,0]
    ds_write_addtid_b32 v117 offset:30016
    ds_write_addtid_b32 v118 offset:32096
    ds_write_addtid_b32 v119 offset:38336
    ds_write_addtid_b32 v120 offset:40416
    v_pk_mul_f16 v121, v145, v138 op_sel:[0,0] op_sel_hi:[0,1]
    v_pk_fma_f16 v121, v145, v138, v121 op_sel:[1,1,0] op_sel_hi:[1,0,1] neg_lo:[0,1,0]
    v_pk_mul_f16 v122, v146, v138 op_sel:[0,0] op_sel_hi:[0,1]
    v_pk_fma_f16 v122, v146, v138, v122 op_sel:[1,1,0] op_sel_hi:[1,0,1] neg_lo:[0,1,0]
    v_pk_mul_f16 v123, v148, v144 op_sel:[0,0] op_sel_hi:[0,1]
    v_pk_fma_f16 v123, v148, v144, v123 op_sel:[1,1,0] op_sel_hi:[1,0,1] neg_lo:[0,1,0]
    v_pk_mul_f16 v124, v148, v145 op_sel:[0,0] op_sel_hi:[0,1]
    v_pk_fma_f16 v124, v148, v145, v124 op_sel:[1,1,0] op_sel_hi:[1,0,1] neg_lo:[0,1,0]
    ds_write_addtid_b32 v121 offset:44576
    ds_write_addtid_b32 v122 offset:54976
    ds_write_addtid_b32 v123 offset:48736
    ds_write_addtid_b32 v124 offset:57056
    v_pk_mul_f16 v125, v148, v146 op_sel:[0,0] op_sel_hi:[0,1]
    v_pk_fma_f16 v125, v148, v146, v125 op_sel:[1,1,0] op_sel_hi:[1,0,1] neg_lo:[0,1,0]
    ds_write_addtid_b32 v125 offset:59136
    s_mov_b32 m0, s52
    s_nop 0
    v_cvt_pk_f16_f32 v141, v66, -v67
    v_cvt_pk_f16_f32 v142, v68, -v69
    v_cvt_pk_f16_f32 v143, v70, -v71
    v_cvt_pk_f16_f32 v150, v82, -v83
    v_pk_mul_f32 v[84:85], v[82:83], v[64:65] op_sel:[0,0] op_sel_hi:[0,1]
    v_pk_fma_f32 v[84:85], v[82:83], v[64:65], v[84:85] op_sel:[1,1,0] op_sel_hi:[1,0,1] neg_lo:[0,1,0]
    v_pk_mul_f16 v126, v150, v141 op_sel:[0,0] op_sel_hi:[0,1]
    v_pk_fma_f16 v126, v150, v141, v126 op_sel:[1,1,0] op_sel_hi:[1,0,1] neg_lo:[0,1,0]
    v_pk_mul_f16 v127, v150, v142 op_sel:[0,0] op_sel_hi:[0,1]
    v_pk_fma_f16 v127, v150, v142, v127 op_sel:[1,1,0] op_sel_hi:[1,0,1] neg_lo:[0,1,0]
    v_pk_mul_f16 v128, v150, v143 op_sel:[0,0] op_sel_hi:[0,1]
    v_pk_fma_f16 v128, v150, v143, v128 op_sel:[1,1,0] op_sel_hi:[1,0,1] neg_lo:[0,1,0]
    ds_write_addtid_b32 v150 offset:0
    ds_write_addtid_b32 v126 offset:16640
    ds_write_addtid_b32 v127 offset:33280
    ds_write_addtid_b32 v128 offset:49920
    v_cvt_pk_f16_f32 v151, v84, -v85
    v_pk_mul_f32 v[82:83], v[84:85], v[64:65] op_sel:[0,0] op_sel_hi:[0,1]
    v_pk_fma_f32 v[82:83], v[84:85], v[64:65], v[82:83] op_sel:[1,1,0] op_sel_hi:[1,0,1] neg_lo:[0,1,0]
    v_pk_mul_f16 v129, v151, v141 op_sel:[0,0] op_sel_hi:[0,1]
    v_pk_fma_f16 v129, v151, v141, v129 op_sel:[1,1,0] op_sel_hi:[1,0,1] neg_lo:[0,1,0]
    v_pk_mul_f16 v114, v151, v142 op_sel:[0,0] op_sel_hi:[0,1]
    v_pk_fma_f16 v114, v151, v142, v114 op_sel:[1,1,0] op_sel_hi:[1,0,1] neg_lo:[0,1,0]
    v_pk_mul_f16 v115, v151, v143 op_sel:[0,0] op_sel_hi:[0,1]
    v_pk_fma_f16 v115, v151, v143, v115 op_sel:[1,1,0] op_sel_hi:[1,0,1] neg_lo:[0,1,0]
    ds_write_addtid_b32 v151 offset:2080
    ds_write_addtid_b32 v129 offset:18720
    ds_write_addtid_b32 v114 offset:35360
    ds_write_addtid_b32 v115 offset:52000
    v_cvt_pk_f16_f32 v152, v82, -v83
    v_pk_mul_f32 v[84:85], v[82:83], v[64:65] op_sel:[0,0] op_sel_hi:[0,1]
    v_pk_fma_f32 v[84:85], v[82:83], v[64:65], v[84:85] op_sel:[1,1,0] op_sel_hi:[1,0,1] neg_lo:[0,1,0]
    v_pk_mul_f16 v116, v152, v141 op_sel:[0,0] op_sel_hi:[0,1]
    v_pk_fma_f16 v116, v152, v141, v116 op_sel:[1,1,0] op_sel_hi:[1,0,1] neg_lo:[0,1,0]
    v_pk_mul_f16 v117, v152, v142 op_sel:[0,0] op_sel_hi:[0,1]
    v_pk_fma_f16 v117, v152, v142, v117 op_sel:[1,1,0] op_sel_hi:[1,0,1] neg_lo:[0,1,0]
    v_pk_mul_f16 v118, v152, v143 op_sel:[0,0] op_sel_hi:[0,1]
    v_pk_fma_f16 v118, v152, v143, v118 op_sel:[1,1,0] op_sel_hi:[1,0,1] neg_lo:[0,1,0]
    ds_write_addtid_b32 v152 offset:4160
    ds_write_addtid_b32 v116 offset:20800
    ds_write_addtid_b32 v117 offset:37440
    ds_write_addtid_b32 v118 offset:54080
    v_cvt_pk_f16_f32 v153, v84, -v85
    v_pk_mul_f32 v[82:83], v[84:85], v[64:65] op_sel:[0,0] op_sel_hi:[0,1]
    v_pk_fma_f32 v[82:83], v[84:85], v[64:65], v[82:83] op_sel:[1,1,0] op_sel_hi:[1,0,1] neg_lo:[0,1,0]
    v_pk_mul_f16 v119, v153, v141 op_sel:[0,0] op_sel_hi:[0,1]
    v_pk_fma_f16 v119, v153, v141, v119 op_sel:[1,1,0] op_sel_hi:[1,0,1] neg_lo:[0,1,0]
    v_pk_mul_f16 v120, v153, v142 op_sel:[0,0] op_sel_hi:[0,1]
    v_pk_fma_f16 v120, v153, v142, v120 op_sel:[1,1,0] op_sel_hi:[1,0,1] neg_lo:[0,1,0]
    v_pk_mul_f16 v121, v153, v143 op_sel:[0,0] op_sel_hi:[0,1]
    v_pk_fma_f16 v121, v153, v143, v121 op_sel:[1,1,0] op_sel_hi:[1,0,1] neg_lo:[0,1,0]
    ds_write_addtid_b32 v153 offset:6240
    ds_write_addtid_b32 v119 offset:22880
    ds_write_addtid_b32 v120 offset:39520
    ds_write_addtid_b32 v121 offset:56160
    v_cvt_pk_f16_f32 v154, v82, -v83
    v_pk_mul_f32 v[84:85], v[82:83], v[64:65] op_sel:[0,0] op_sel_hi:[0,1]
    v_pk_fma_f32 v[84:85], v[82:83], v[64:65], v[84:85] op_sel:[1,1,0] op_sel_hi:[1,0,1] neg_lo:[0,1,0]
    v_pk_mul_f16 v122, v154, v141 op_sel:[0,0] op_sel_hi:[0,1]
    v_pk_fma_f16 v122, v154, v141, v122 op_sel:[1,1,0] op_sel_hi:[1,0,1] neg_lo:[0,1,0]
    v_pk_mul_f16 v123, v154, v142 op_sel:[0,0] op_sel_hi:[0,1]
    v_pk_fma_f16 v123, v154, v142, v123 op_sel:[1,1,0] op_sel_hi:[1,0,1] neg_lo:[0,1,0]
    v_pk_mul_f16 v124, v154, v143 op_sel:[0,0] op_sel_hi:[0,1]
    v_pk_fma_f16 v124, v154, v143, v124 op_sel:[1,1,0] op_sel_hi:[1,0,1] neg_lo:[0,1,0]
    ds_write_addtid_b32 v154 offset:8320
    ds_write_addtid_b32 v122 offset:24960
    ds_write_addtid_b32 v123 offset:41600
    ds_write_addtid_b32 v124 offset:58240
    v_cvt_pk_f16_f32 v155, v84, -v85
    v_pk_mul_f32 v[82:83], v[84:85], v[64:65] op_sel:[0,0] op_sel_hi:[0,1]
    v_pk_fma_f32 v[82:83], v[84:85], v[64:65], v[82:83] op_sel:[1,1,0] op_sel_hi:[1,0,1] neg_lo:[0,1,0]
    v_pk_mul_f16 v125, v155, v141 op_sel:[0,0] op_sel_hi:[0,1]
    v_pk_fma_f16 v125, v155, v141, v125 op_sel:[1,1,0] op_sel_hi:[1,0,1] neg_lo:[0,1,0]
    v_pk_mul_f16 v126, v155, v142 op_sel:[0,0] op_sel_hi:[0,1]
    v_pk_fma_f16 v126, v155, v142, v126 op_sel:[1,1,0] op_sel_hi:[1,0,1] neg_lo:[0,1,0]
    v_pk_mul_f16 v127, v155, v143 op_sel:[0,0] op_sel_hi:[0,1]
    v_pk_fma_f16 v127, v155, v143, v127 op_sel:[1,1,0] op_sel_hi:[1,0,1] neg_lo:[0,1,0]
    ds_write_addtid_b32 v155 offset:10400
    ds_write_addtid_b32 v125 offset:27040
    ds_write_addtid_b32 v126 offset:43680
    ds_write_addtid_b32 v127 offset:60320
    v_cvt_pk_f16_f32 v156, v82, -v83
    v_pk_mul_f32 v[84:85], v[82:83], v[64:65] op_sel:[0,0] op_sel_hi:[0,1]
    v_pk_fma_f32 v[84:85], v[82:83], v[64:65], v[84:85] op_sel:[1,1,0] op_sel_hi:[1,0,1] neg_lo:[0,1,0]
    v_pk_mul_f16 v128, v156, v141 op_sel:[0,0] op_sel_hi:[0,1]
    v_pk_fma_f16 v128, v156, v141, v128 op_sel:[1,1,0] op_sel_hi:[1,0,1] neg_lo:[0,1,0]
    v_pk_mul_f16 v129, v156, v142 op_sel:[0,0] op_sel_hi:[0,1]
    v_pk_fma_f16 v129, v156, v142, v129 op_sel:[1,1,0] op_sel_hi:[1,0,1] neg_lo:[0,1,0]
    v_pk_mul_f16 v114, v156, v143 op_sel:[0,0] op_sel_hi:[0,1]
    v_pk_fma_f16 v114, v156, v143, v114 op_sel:[1,1,0] op_sel_hi:[1,0,1] neg_lo:[0,1,0]
    ds_write_addtid_b32 v156 offset:12480
    ds_write_addtid_b32 v128 offset:29120
    ds_write_addtid_b32 v129 offset:45760
    ds_write_addtid_b32 v114 offset:62400
    v_cvt_pk_f16_f32 v157, v84, -v85
    v_pk_mul_f16 v115, v157, v141 op_sel:[0,0] op_sel_hi:[0,1]
    v_pk_fma_f16 v115, v157, v141, v115 op_sel:[1,1,0] op_sel_hi:[1,0,1] neg_lo:[0,1,0]
    v_pk_mul_f16 v116, v157, v142 op_sel:[0,0] op_sel_hi:[0,1]
    v_pk_fma_f16 v116, v157, v142, v116 op_sel:[1,1,0] op_sel_hi:[1,0,1] neg_lo:[0,1,0]
    v_pk_mul_f16 v117, v157, v143 op_sel:[0,0] op_sel_hi:[0,1]
    v_pk_fma_f16 v117, v157, v143, v117 op_sel:[1,1,0] op_sel_hi:[1,0,1] neg_lo:[0,1,0]
    ds_write_addtid_b32 v157 offset:14560
    ds_write_addtid_b32 v115 offset:31200
    ds_write_addtid_b32 v116 offset:47840
    ds_write_addtid_b32 v117 offset:64480
    ds_read_b128 v[176:179], v34 offset:0
    ds_read_b128 v[208:211], v35 offset:0
    ds_read_b128 v[180:183], v34 offset:64
    ds_read_b128 v[212:215], v35 offset:64
    ds_read_b128 v[184:187], v34 offset:128
    ds_read_b128 v[216:219], v35 offset:128
    ds_read_b128 v[188:191], v34 offset:192
    ds_read_b128 v[220:223], v35 offset:192
    ds_read_b128 v[224:227], v35 offset:33280
    ds_read_b128 v[228:231], v35 offset:33344
    ds_read_b128 v[232:235], v35 offset:33408
    ds_read_b128 v[236:239], v35 offset:33472
    ds_read_b128 v[192:195], v132 offset:18720
    ds_read_b128 v[196:199], v132 offset:18784
    ds_read_b128 v[200:203], v132 offset:18848
    ds_read_b128 v[204:207], v132 offset:18912
    s_cmp_eq_u32 s3, 0
    s_cbranch_scc1 L_b_side0
L_b_sb0:
    s_setprio 2
    v_mul_f32 v6, s58, v6
    v_mul_f32_e64 v99, s54, v7
    v_exp_f32 v6, v6
    v_mul_f32 v99, s59, v99
    v_cvt_pk_bf16_f32 v6, v6, v6
    v_lshlrev_b32_e64 v6, 16, v6
    v_fract_f32 v100, v99
    v_mul_f32 v98, s54, v6
    v_mul_f32 v101, 0x42800000, v99
    v_mul_f32 v98, s58, v98
    v_fract_f32 v101, v101
    v_mul_f32 v103, 0x42800000, v98
    v_cos_f32 v56, v100
    v_sin_f32 v57, v100
    v_exp_f32 v102, -v98
    v_cos_f32 v66, v101
    v_sin_f32 v67, v101
    v_exp_f32 v104, -v103
    v_pk_mul_f32 v[56:57], v[56:57], v[102:103] op_sel_hi:[1,0]
    v_pk_mul_f32 v[82:83], v[8:9], s[56:57] op_sel_hi:[1,0]
    v_pk_mul_f32 v[66:67], v[66:67], v[104:105] op_sel_hi:[1,0]
    s_mov_b32 m0, s53
    s_waitcnt lgkmcnt(14)
    v_mfma_f32_16x16x32_f16 v[40:43], v[176:179], v[208:211], 0
    v_cvt_pk_f16_f32 v136, v56, v57
    s_waitcnt lgkmcnt(12)
    v_mfma_f32_16x16x32_f16 v[40:43], v[180:183], v[212:215], v[40:43]
    v_pk_mul_f32 v[58:59], v[56:57], v[56:57] op_sel:[0,0] op_sel_hi:[0,1]
    v_pk_fma_f32 v[58:59], v[56:57], v[56:57], v[58:59] op_sel:[1,1,0] op_sel_hi:[1,0,1] neg_lo:[0,1,0]
    s_waitcnt lgkmcnt(10)
    v_mfma_f32_16x16x32_f16 v[40:43], v[184:187], v[216:219], v[40:43]
    v_cvt_pk_f16_f32 v137, v58, v59
    s_waitcnt lgkmcnt(8)
    v_mfma_f32_16x16x32_f16 v[40:43], v[188:191], v[220:223], v[40:43]
    v_pk_mul_f32 v[60:61], v[58:59], v[58:59] op_sel:[0,0] op_sel_hi:[0,1]
    v_pk_fma_f32 v[60:61], v[58:59], v[58:59], v[60:61] op_sel:[1,1,0] op_sel_hi:[1,0,1] neg_lo:[0,1,0]
    s_waitcnt lgkmcnt(7)
    v_mfma_f32_16x16x32_f16 v[44:47], v[176:179], v[224:227], 0
    v_cvt_pk_f16_f32 v138, v60, v61
    s_waitcnt lgkmcnt(6)
    v_mfma_f32_16x16x32_f16 v[44:47], v[180:183], v[228:231], v[44:47]
    v_pk_mul_f32 v[64:65], v[60:61], v[60:61] op_sel:[0,0] op_sel_hi:[0,1]
    v_pk_fma_f32 v[64:65], v[60:61], v[60:61], v[64:65] op_sel:[1,1,0] op_sel_hi:[1,0,1] neg_lo:[0,1,0]
    s_waitcnt lgkmcnt(5)
    v_mfma_f32_16x16x32_f16 v[44:47], v[184:187], v[232:235], v[44:47]
    v_cvt_pk_f16_f32 v140, v64, v65
    v_pk_mul_f32 v[62:63], v[60:61], v[58:59] op_sel:[0,0] op_sel_hi:[0,1]
    s_waitcnt lgkmcnt(4)
    v_mfma_f32_16x16x32_f16 v[44:47], v[188:191], v[236:239], v[44:47]
    v_pk_fma_f32 v[62:63], v[60:61], v[58:59], v[62:63] op_sel:[1,1,0] op_sel_hi:[1,0,1] neg_lo:[0,1,0]
    v_cvt_pk_f16_f32 v139, v62, v63
    s_waitcnt lgkmcnt(3)
    v_mfma_f32_16x16x32_f16 v[52:55], v[192:195], v[224:227], 0
    ds_write_addtid_b32 v136 offset:11296
    ds_write_addtid_b32 v137 offset:13376
    ds_write_addtid_b32 v138 offset:17536
    ds_write_addtid_b32 v139 offset:21696
    v_pk_mul_f32 v[68:69], v[66:67], v[66:67] op_sel:[0,0] op_sel_hi:[0,1]
    s_waitcnt lgkmcnt(6)
    v_mfma_f32_16x16x32_f16 v[52:55], v[196:199], v[228:231], v[52:55]
    v_pk_fma_f32 v[68:69], v[66:67], v[66:67], v[68:69] op_sel:[1,1,0] op_sel_hi:[1,0,1] neg_lo:[0,1,0]
    v_pk_mul_f32 v[72:73], v[68:69], v[68:69] op_sel:[0,0] op_sel_hi:[0,1]
    s_waitcnt lgkmcnt(5)
    v_mfma_f32_16x16x32_f16 v[52:55], v[200:203], v[232:235], v[52:55]
    v_pk_fma_f32 v[72:73], v[68:69], v[68:69], v[72:73] op_sel:[1,1,0] op_sel_hi:[1,0,1] neg_lo:[0,1,0]
    v_cvt_pk_f16_f32 v144, v72, v73
    s_waitcnt lgkmcnt(4)
    s_nop 0
    v_mfma_f32_16x16x32_f16 v[52:55], v[204:207], v[236:239], v[52:55]
    v_pk_mul_f32 v[74:75], v[72:73], v[72:73] op_sel:[0,0] op_sel_hi:[0,1]
    v_mfma_f32_16x16x32_f16 v[48:51], v[192:195], v[208:211], 0
    v_pk_fma_f32 v[74:75], v[72:73], v[72:73], v[74:75] op_sel:[1,1,0] op_sel_hi:[1,0,1] neg_lo:[0,1,0]
    v_cvt_pk_f16_f32 v145, v74, v75
    v_mfma_f32_16x16x32_f16 v[48:51], v[196:199], v[212:215], v[48:51]
    v_pk_mul_f32 v[76:77], v[74:75], v[72:73] op_sel:[0,0] op_sel_hi:[0,1]
    v_mfma_f32_16x16x32_f16 v[48:51], v[200:203], v[216:219], v[48:51]
    v_pk_fma_f32 v[76:77], v[74:75], v[72:73], v[76:77] op_sel:[1,1,0] op_sel_hi:[1,0,1] neg_lo:[0,1,0]
    v_cvt_pk_f16_f32 v146, v76, v77
    v_mfma_f32_16x16x32_f16 v[48:51], v[204:207], v[220:223], v[48:51]
    v_pk_mul_f32 v[78:79], v[74:75], v[74:75] op_sel:[0,0] op_sel_hi:[0,1]
    v_pk_fma_f32 v[78:79], v[74:75], v[74:75], v[78:79] op_sel:[1,1,0] op_sel_hi:[1,0,1] neg_lo:[0,1,0]
    v_cvt_pk_f16_f32 v147, v78, v79
    ds_write_addtid_b32 v144 offset:25856
    ds_write_addtid_b32 v145 offset:42496
    ds_write_addtid_b32 v146 offset:52896
    ds_write_addtid_b32 v147 offset:50816
    v_pk_mul_f32 v[80:81], v[78:79], v[64:65] op_sel:[0,0] op_sel_hi:[0,1]
    v_pk_fma_f32 v[80:81], v[78:79], v[64:65], v[80:81] op_sel:[1,1,0] op_sel_hi:[1,0,1] neg_lo:[0,1,0]
    v_cvt_pk_f16_f32 v148, v80, v81
    v_pk_mul_f32 v[70:71], v[68:69], v[66:67] op_sel:[0,0] op_sel_hi:[0,1]
    v_pk_fma_f32 v[70:71], v[68:69], v[66:67], v[70:71] op_sel:[1,1,0] op_sel_hi:[1,0,1] neg_lo:[0,1,0]
    v_pk_mul_f16 v118, v137, v136 op_sel:[0,0] op_sel_hi:[0,1]
    v_pk_fma_f16 v118, v137, v136, v118 op_sel:[1,1,0] op_sel_hi:[1,0,1] neg_lo:[0,1,0]
    v_pk_mul_f16 v119, v138, v136 op_sel:[0,0] op_sel_hi:[0,1]
    v_pk_fma_f16 v119, v138, v136, v119 op_sel:[1,1,0] op_sel_hi:[1,0,1] neg_lo:[0,1,0]
    v_pk_mul_f16 v120, v139, v136 op_sel:[0,0] op_sel_hi:[0,1]
    v_pk_fma_f16 v120, v139, v136, v120 op_sel:[1,1,0] op_sel_hi:[1,0,1] neg_lo:[0,1,0]
    ds_write_addtid_b32 v148 offset:46656
    ds_write_addtid_b32 v118 offset:15456
    ds_write_addtid_b32 v119 offset:19616
    ds_write_addtid_b32 v120 offset:23776
    v_pk_mul_f16 v121, v144, v137 op_sel:[0,0] op_sel_hi:[0,1]
    v_pk_fma_f16 v121, v144, v137, v121 op_sel:[1,1,0] op_sel_hi:[1,0,1] neg_lo:[0,1,0]
    v_pk_mul_f16 v122, v144, v138 op_sel:[0,0] op_sel_hi:[0,1]
    v_pk_fma_f16 v122, v144, v138, v122 op_sel:[1,1,0] op_sel_hi:[1,0,1] neg_lo:[0,1,0]
    v_pk_mul_f16 v123, v144, v139 op_sel:[0,0] op_sel_hi:[0,1]
    v_pk_fma_f16 v123, v144, v139, v123 op_sel:[1,1,0] op_sel_hi:[1,0,1] neg_lo:[0,1,0]
    v_pk_mul_f16 v124, v144, v140 op_sel:[0,0] op_sel_hi:[0,1]
    v_pk_fma_f16 v124, v144, v140, v124 op_sel:[1,1,0] op_sel_hi:[1,0,1] neg_lo:[0,1,0]
    ds_write_addtid_b32 v121 offset:30016
    ds_write_addtid_b32 v122 offset:32096
    ds_write_addtid_b32 v123 offset:38336
    ds_write_addtid_b32 v124 offset:40416
    v_pk_mul_f16 v125, v145, v138 op_sel:[0,0] op_sel_hi:[0,1]
    v_pk_fma_f16 v125, v145, v138, v125 op_sel:[1,1,0] op_sel_hi:[1,0,1] neg_lo:[0,1,0]
    v_pk_mul_f16 v126, v146, v138 op_sel:[0,0] op_sel_hi:[0,1]
    v_pk_fma_f16 v126, v146, v138, v126 op_sel:[1,1,0] op_sel_hi:[1,0,1] neg_lo:[0,1,0]
    v_pk_mul_f16 v127, v148, v144 op_sel:[0,0] op_sel_hi:[0,1]
    v_pk_fma_f16 v127, v148, v144, v127 op_sel:[1,1,0] op_sel_hi:[1,0,1] neg_lo:[0,1,0]
    v_pk_mul_f16 v128, v148, v145 op_sel:[0,0] op_sel_hi:[0,1]
    v_pk_fma_f16 v128, v148, v145, v128 op_sel:[1,1,0] op_sel_hi:[1,0,1] neg_lo:[0,1,0]
    ds_write_addtid_b32 v125 offset:44576
    ds_write_addtid_b32 v126 offset:54976
    ds_write_addtid_b32 v127 offset:48736
    ds_write_addtid_b32 v128 offset:57056
    v_pk_mul_f16 v129, v148, v146 op_sel:[0,0] op_sel_hi:[0,1]
    v_pk_fma_f16 v129, v148, v146, v129 op_sel:[1,1,0] op_sel_hi:[1,0,1] neg_lo:[0,1,0]
    ds_write_addtid_b32 v129 offset:59136
    s_mov_b32 m0, s52
    s_nop 0
    v_cvt_pk_f16_f32 v141, v66, -v67
    v_cvt_pk_f16_f32 v142, v68, -v69
    v_cvt_pk_f16_f32 v143, v70, -v71
    v_cvt_pk_f16_f32 v150, v82, -v83
    v_pk_mul_f32 v[84:85], v[82:83], v[64:65] op_sel:[0,0] op_sel_hi:[0,1]
    v_pk_fma_f32 v[84:85], v[82:83], v[64:65], v[84:85] op_sel:[1,1,0] op_sel_hi:[1,0,1] neg_lo:[0,1,0]
    v_pk_mul_f16 v114, v150, v141 op_sel:[0,0] op_sel_hi:[0,1]
    v_pk_fma_f16 v114, v150, v141, v114 op_sel:[1,1,0] op_sel_hi:[1,0,1] neg_lo:[0,1,0]
    v_pk_mul_f16 v115, v150, v142 op_sel:[0,0] op_sel_hi:[0,1]
    v_pk_fma_f16 v115, v150, v142, v115 op_sel:[1,1,0] op_sel_hi:[1,0,1] neg_lo:[0,1,0]
    v_pk_mul_f16 v116, v150, v143 op_sel:[0,0] op_sel_hi:[0,1]
    v_pk_fma_f16 v116, v150, v143, v116 op_sel:[1,1,0] op_sel_hi:[1,0,1] neg_lo:[0,1,0]
    ds_write_addtid_b32 v150 offset:0
    ds_write_addtid_b32 v114 offset:16640
    ds_write_addtid_b32 v115 offset:33280
    ds_write_addtid_b32 v116 offset:49920
    v_cvt_pk_f16_f32 v151, v84, -v85
    v_pk_mul_f32 v[82:83], v[84:85], v[64:65] op_sel:[0,0] op_sel_hi:[0,1]
    v_pk_fma_f32 v[82:83], v[84:85], v[64:65], v[82:83] op_sel:[1,1,0] op_sel_hi:[1,0,1] neg_lo:[0,1,0]
    v_pk_mul_f16 v117, v151, v141 op_sel:[0,0] op_sel_hi:[0,1]
    v_pk_fma_f16 v117, v151, v141, v117 op_sel:[1,1,0] op_sel_hi:[1,0,1] neg_lo:[0,1,0]
    v_pk_mul_f16 v118, v151, v142 op_sel:[0,0] op_sel_hi:[0,1]
    v_pk_fma_f16 v118, v151, v142, v118 op_sel:[1,1,0] op_sel_hi:[1,0,1] neg_lo:[0,1,0]
    v_pk_mul_f16 v119, v151, v143 op_sel:[0,0] op_sel_hi:[0,1]
    v_pk_fma_f16 v119, v151, v143, v119 op_sel:[1,1,0] op_sel_hi:[1,0,1] neg_lo:[0,1,0]
    ds_write_addtid_b32 v151 offset:2080
    ds_write_addtid_b32 v117 offset:18720
    ds_write_addtid_b32 v118 offset:35360
    ds_write_addtid_b32 v119 offset:52000
    v_cvt_pk_f16_f32 v152, v82, -v83
    v_pk_mul_f32 v[84:85], v[82:83], v[64:65] op_sel:[0,0] op_sel_hi:[0,1]
    v_pk_fma_f32 v[84:85], v[82:83], v[64:65], v[84:85] op_sel:[1,1,0] op_sel_hi:[1,0,1] neg_lo:[0,1,0]
    v_pk_mul_f16 v120, v152, v141 op_sel:[0,0] op_sel_hi:[0,1]
    v_pk_fma_f16 v120, v152, v141, v120 op_sel:[1,1,0] op_sel_hi:[1,0,1] neg_lo:[0,1,0]
    v_pk_mul_f16 v121, v152, v142 op_sel:[0,0] op_sel_hi:[0,1]
    v_pk_fma_f16 v121, v152, v142, v121 op_sel:[1,1,0] op_sel_hi:[1,0,1] neg_lo:[0,1,0]
    v_pk_mul_f16 v122, v152, v143 op_sel:[0,0] op_sel_hi:[0,1]
    v_pk_fma_f16 v122, v152, v143, v122 op_sel:[1,1,0] op_sel_hi:[1,0,1] neg_lo:[0,1,0]
    ds_write_addtid_b32 v152 offset:4160
    ds_write_addtid_b32 v120 offset:20800
    ds_write_addtid_b32 v121 offset:37440
    ds_write_addtid_b32 v122 offset:54080
    v_cvt_pk_f16_f32 v153, v84, -v85
    v_pk_mul_f32 v[82:83], v[84:85], v[64:65] op_sel:[0,0] op_sel_hi:[0,1]
    v_pk_fma_f32 v[82:83], v[84:85], v[64:65], v[82:83] op_sel:[1,1,0] op_sel_hi:[1,0,1] neg_lo:[0,1,0]
    v_pk_mul_f16 v123, v153, v141 op_sel:[0,0] op_sel_hi:[0,1]
    v_pk_fma_f16 v123, v153, v141, v123 op_sel:[1,1,0] op_sel_hi:[1,0,1] neg_lo:[0,1,0]
    v_pk_mul_f16 v124, v153, v142 op_sel:[0,0] op_sel_hi:[0,1]
    v_pk_fma_f16 v124, v153, v142, v124 op_sel:[1,1,0] op_sel_hi:[1,0,1] neg_lo:[0,1,0]
    v_pk_mul_f16 v125, v153, v143 op_sel:[0,0] op_sel_hi:[0,1]
    v_pk_fma_f16 v125, v153, v143, v125 op_sel:[1,1,0] op_sel_hi:[1,0,1] neg_lo:[0,1,0]
    ds_write_addtid_b32 v153 offset:6240
    ds_write_addtid_b32 v123 offset:22880
    ds_write_addtid_b32 v124 offset:39520
    ds_write_addtid_b32 v125 offset:56160
    v_cvt_pk_f16_f32 v154, v82, -v83
    v_pk_mul_f32 v[84:85], v[82:83], v[64:65] op_sel:[0,0] op_sel_hi:[0,1]
    v_pk_fma_f32 v[84:85], v[82:83], v[64:65], v[84:85] op_sel:[1,1,0] op_sel_hi:[1,0,1] neg_lo:[0,1,0]
    v_pk_mul_f16 v126, v154, v141 op_sel:[0,0] op_sel_hi:[0,1]
    v_pk_fma_f16 v126, v154, v141, v126 op_sel:[1,1,0] op_sel_hi:[1,0,1] neg_lo:[0,1,0]
    v_pk_mul_f16 v127, v154, v142 op_sel:[0,0] op_sel_hi:[0,1]
    v_pk_fma_f16 v127, v154, v142, v127 op_sel:[1,1,0] op_sel_hi:[1,0,1] neg_lo:[0,1,0]
    v_pk_mul_f16 v128, v154, v143 op_sel:[0,0] op_sel_hi:[0,1]
    v_pk_fma_f16 v128, v154, v143, v128 op_sel:[1,1,0] op_sel_hi:[1,0,1] neg_lo:[0,1,0]
    ds_write_addtid_b32 v154 offset:8320
    ds_write_addtid_b32 v126 offset:24960
    ds_write_addtid_b32 v127 offset:41600
    ds_write_addtid_b32 v128 offset:58240
    v_cvt_pk_f16_f32 v155, v84, -v85
    v_pk_mul_f32 v[82:83], v[84:85], v[64:65] op_sel:[0,0] op_sel_hi:[0,1]
    v_pk_fma_f32 v[82:83], v[84:85], v[64:65], v[82:83] op_sel:[1,1,0] op_sel_hi:[1,0,1] neg_lo:[0,1,0]
    v_pk_mul_f16 v129, v155, v141 op_sel:[0,0] op_sel_hi:[0,1]
    v_pk_fma_f16 v129, v155, v141, v129 op_sel:[1,1,0] op_sel_hi:[1,0,1] neg_lo:[0,1,0]
    v_pk_mul_f16 v114, v155, v142 op_sel:[0,0] op_sel_hi:[0,1]
    v_pk_fma_f16 v114, v155, v142, v114 op_sel:[1,1,0] op_sel_hi:[1,0,1] neg_lo:[0,1,0]
    v_pk_mul_f16 v115, v155, v143 op_sel:[0,0] op_sel_hi:[0,1]
    v_pk_fma_f16 v115, v155, v143, v115 op_sel:[1,1,0] op_sel_hi:[1,0,1] neg_lo:[0,1,0]
    ds_write_addtid_b32 v155 offset:10400
    ds_write_addtid_b32 v129 offset:27040
    ds_write_addtid_b32 v114 offset:43680
    ds_write_addtid_b32 v115 offset:60320
    v_cvt_pk_f16_f32 v156, v82, -v83
    v_pk_mul_f32 v[84:85], v[82:83], v[64:65] op_sel:[0,0] op_sel_hi:[0,1]
    v_pk_fma_f32 v[84:85], v[82:83], v[64:65], v[84:85] op_sel:[1,1,0] op_sel_hi:[1,0,1] neg_lo:[0,1,0]
    v_pk_mul_f16 v116, v156, v141 op_sel:[0,0] op_sel_hi:[0,1]
    v_pk_fma_f16 v116, v156, v141, v116 op_sel:[1,1,0] op_sel_hi:[1,0,1] neg_lo:[0,1,0]
    v_pk_mul_f16 v117, v156, v142 op_sel:[0,0] op_sel_hi:[0,1]
    v_pk_fma_f16 v117, v156, v142, v117 op_sel:[1,1,0] op_sel_hi:[1,0,1] neg_lo:[0,1,0]
    v_pk_mul_f16 v118, v156, v143 op_sel:[0,0] op_sel_hi:[0,1]
    v_pk_fma_f16 v118, v156, v143, v118 op_sel:[1,1,0] op_sel_hi:[1,0,1] neg_lo:[0,1,0]
    ds_write_addtid_b32 v156 offset:12480
    ds_write_addtid_b32 v116 offset:29120
    ds_write_addtid_b32 v117 offset:45760
    ds_write_addtid_b32 v118 offset:62400
    v_cvt_pk_f16_f32 v157, v84, -v85
    v_pk_mul_f16 v119, v157, v141 op_sel:[0,0] op_sel_hi:[0,1]
    v_pk_fma_f16 v119, v157, v141, v119 op_sel:[1,1,0] op_sel_hi:[1,0,1] neg_lo:[0,1,0]
    v_pk_mul_f16 v120, v157, v142 op_sel:[0,0] op_sel_hi:[0,1]
    v_pk_fma_f16 v120, v157, v142, v120 op_sel:[1,1,0] op_sel_hi:[1,0,1] neg_lo:[0,1,0]
    v_pk_mul_f16 v121, v157, v143 op_sel:[0,0] op_sel_hi:[0,1]
    v_pk_fma_f16 v121, v157, v143, v121 op_sel:[1,1,0] op_sel_hi:[1,0,1] neg_lo:[0,1,0]
    ds_write_addtid_b32 v157 offset:14560
    ds_write_addtid_b32 v119 offset:31200
    ds_write_addtid_b32 v120 offset:47840
    ds_write_addtid_b32 v121 offset:64480
    ds_read_b128 v[176:179], v34 offset:0
    ds_read_b128 v[208:211], v35 offset:0
    ds_read_b128 v[180:183], v34 offset:64
    ds_read_b128 v[212:215], v35 offset:64
    ds_read_b128 v[184:187], v34 offset:128
    ds_read_b128 v[216:219], v35 offset:128
    ds_read_b128 v[188:191], v34 offset:192
    ds_read_b128 v[220:223], v35 offset:192
    ds_read_b128 v[224:227], v35 offset:33280
    ds_read_b128 v[228:231], v35 offset:33344
    ds_read_b128 v[232:235], v35 offset:33408
    ds_read_b128 v[236:239], v35 offset:33472
    ds_read_b128 v[192:195], v132 offset:18720
    ds_read_b128 v[196:199], v132 offset:18784
    ds_read_b128 v[200:203], v132 offset:18848
    ds_read_b128 v[204:207], v132 offset:18912
    s_cmp_eq_u32 s3, 0
    s_cbranch_scc1 L_b_side1
L_b_sb1:
    s_setprio 1
    v_mul_f32 v10, s58, v10
    v_mul_f32_e64 v99, s54, v11
    v_exp_f32 v10, v10
    v_mul_f32 v99, s59, v99
    v_cvt_pk_bf16_f32 v10, v10, v10
    v_lshlrev_b32_e64 v10, 16, v10
    v_fract_f32 v100, v99
    v_mul_f32 v98, s54, v10
    v_mul_f32 v101, 0x42800000, v99
    v_mul_f32 v98, s58, v98
    v_fract_f32 v101, v101
    v_mul_f32 v103, 0x42800000, v98
    v_cos_f32 v56, v100
    v_sin_f32 v57, v100
    v_exp_f32 v102, -v98
    v_cos_f32 v66, v101
    v_sin_f32 v67, v101
    v_exp_f32 v104, -v103
    v_pk_mul_f32 v[56:57], v[56:57], v[102:103] op_sel_hi:[1,0]
    v_pk_mul_f32 v[82:83], v[12:13], s[56:57] op_sel_hi:[1,0]
    v_pk_mul_f32 v[66:67], v[66:67], v[104:105] op_sel_hi:[1,0]
    s_mov_b32 m0, s53
    s_waitcnt lgkmcnt(14)
    v_mfma_f32_16x16x32_f16 v[40:43], v[176:179], v[208:211], v[40:43]
    v_cvt_pk_f16_f32 v136, v56, v57
    s_waitcnt lgkmcnt(12)
    v_mfma_f32_16x16x32_f16 v[40:43], v[180:183], v[212:215], v[40:43]
    v_pk_mul_f32 v[58:59], v[56:57], v[56:57] op_sel:[0,0] op_sel_hi:[0,1]
    v_pk_fma_f32 v[58:59], v[56:57], v[56:57], v[58:59] op_sel:[1,1,0] op_sel_hi:[1,0,1] neg_lo:[0,1,0]
    s_waitcnt lgkmcnt(10)
    v_mfma_f32_16x16x32_f16 v[40:43], v[184:187], v[216:219], v[40:43]
    v_cvt_pk_f16_f32 v137, v58, v59
    s_waitcnt lgkmcnt(8)
    v_mfma_f32_16x16x32_f16 v[40:43], v[188:191], v[220:223], v[40:43]
    v_pk_mul_f32 v[60:61], v[58:59], v[58:59] op_sel:[0,0] op_sel_hi:[0,1]
    v_pk_fma_f32 v[60:61], v[58:59], v[58:59], v[60:61] op_sel:[1,1,0] op_sel_hi:[1,0,1] neg_lo:[0,1,0]
    s_waitcnt lgkmcnt(7)
    v_mfma_f32_16x16x32_f16 v[44:47], v[176:179], v[224:227], v[44:47]
    v_cvt_pk_f16_f32 v138, v60, v61
    s_waitcnt lgkmcnt(6)
    v_mfma_f32_16x16x32_f16 v[44:47], v[180:183], v[228:231], v[44:47]
    v_pk_mul_f32 v[64:65], v[60:61], v[60:61] op_sel:[0,0] op_sel_hi:[0,1]
    v_pk_fma_f32 v[64:65], v[60:61], v[60:61], v[64:65] op_sel:[1,1,0] op_sel_hi:[1,0,1] neg_lo:[0,1,0]
    s_waitcnt lgkmcnt(5)
    v_mfma_f32_16x16x32_f16 v[44:47], v[184:187], v[232:235], v[44:47]
    v_cvt_pk_f16_f32 v140, v64, v65
    v_pk_mul_f32 v[62:63], v[60:61], v[58:59] op_sel:[0,0] op_sel_hi:[0,1]
    s_waitcnt lgkmcnt(4)
    v_mfma_f32_16x16x32_f16 v[44:47], v[188:191], v[236:239], v[44:47]
    v_pk_fma_f32 v[62:63], v[60:61], v[58:59], v[62:63] op_sel:[1,1,0] op_sel_hi:[1,0,1] neg_lo:[0,1,0]
    v_cvt_pk_f16_f32 v139, v62, v63
    s_waitcnt lgkmcnt(3)
    v_mfma_f32_16x16x32_f16 v[52:55], v[192:195], v[224:227], v[52:55]
    ds_write_addtid_b32 v136 offset:11296
    ds_write_addtid_b32 v137 offset:13376
    ds_write_addtid_b32 v138 offset:17536
    ds_write_addtid_b32 v139 offset:21696
    v_pk_mul_f32 v[68:69], v[66:67], v[66:67] op_sel:[0,0] op_sel_hi:[0,1]
    s_waitcnt lgkmcnt(6)
    v_mfma_f32_16x16x32_f16 v[52:55], v[196:199], v[228:231], v[52:55]
    v_pk_fma_f32 v[68:69], v[66:67], v[66:67], v[68:69] op_sel:[1,1,0] op_sel_hi:[1,0,1] neg_lo:[0,1,0]
    v_pk_mul_f32 v[72:73], v[68:69], v[68:69] op_sel:[0,0] op_sel_hi:[0,1]
    s_waitcnt lgkmcnt(5)
    v_mfma_f32_16x16x32_f16 v[52:55], v[200:203], v[232:235], v[52:55]
    v_pk_fma_f32 v[72:73], v[68:69], v[68:69], v[72:73] op_sel:[1,1,0] op_sel_hi:[1,0,1] neg_lo:[0,1,0]
    v_cvt_pk_f16_f32 v144, v72, v73
    s_waitcnt lgkmcnt(4)
    s_nop 0
    v_mfma_f32_16x16x32_f16 v[52:55], v[204:207], v[236:239], v[52:55]
    v_pk_mul_f32 v[74:75], v[72:73], v[72:73] op_sel:[0,0] op_sel_hi:[0,1]
    v_mfma_f32_16x16x32_f16 v[48:51], v[192:195], v[208:211], v[48:51]
    v_pk_fma_f32 v[74:75], v[72:73], v[72:73], v[74:75] op_sel:[1,1,0] op_sel_hi:[1,0,1] neg_lo:[0,1,0]
    v_cvt_pk_f16_f32 v145, v74, v75
    v_mfma_f32_16x16x32_f16 v[48:51], v[196:199], v[212:215], v[48:51]
    v_pk_mul_f32 v[76:77], v[74:75], v[72:73] op_sel:[0,0] op_sel_hi:[0,1]
    v_mfma_f32_16x16x32_f16 v[48:51], v[200:203], v[216:219], v[48:51]
    v_pk_fma_f32 v[76:77], v[74:75], v[72:73], v[76:77] op_sel:[1,1,0] op_sel_hi:[1,0,1] neg_lo:[0,1,0]
    v_cvt_pk_f16_f32 v146, v76, v77
    v_mfma_f32_16x16x32_f16 v[48:51], v[204:207], v[220:223], v[48:51]
    v_pk_mul_f32 v[78:79], v[74:75], v[74:75] op_sel:[0,0] op_sel_hi:[0,1]
    v_pk_fma_f32 v[78:79], v[74:75], v[74:75], v[78:79] op_sel:[1,1,0] op_sel_hi:[1,0,1] neg_lo:[0,1,0]
    v_cvt_pk_f16_f32 v147, v78, v79
    ds_write_addtid_b32 v144 offset:25856
    ds_write_addtid_b32 v145 offset:42496
    ds_write_addtid_b32 v146 offset:52896
    ds_write_addtid_b32 v147 offset:50816
    v_pk_mul_f32 v[80:81], v[78:79], v[64:65] op_sel:[0,0] op_sel_hi:[0,1]
    v_pk_fma_f32 v[80:81], v[78:79], v[64:65], v[80:81] op_sel:[1,1,0] op_sel_hi:[1,0,1] neg_lo:[0,1,0]
    v_cvt_pk_f16_f32 v148, v80, v81
    v_pk_mul_f32 v[70:71], v[68:69], v[66:67] op_sel:[0,0] op_sel_hi:[0,1]
    v_pk_fma_f32 v[70:71], v[68:69], v[66:67], v[70:71] op_sel:[1,1,0] op_sel_hi:[1,0,1] neg_lo:[0,1,0]
    v_pk_mul_f16 v122, v137, v136 op_sel:[0,0] op_sel_hi:[0,1]
    v_pk_fma_f16 v122, v137, v136, v122 op_sel:[1,1,0] op_sel_hi:[1,0,1] neg_lo:[0,1,0]
    v_pk_mul_f16 v123, v138, v136 op_sel:[0,0] op_sel_hi:[0,1]
    v_pk_fma_f16 v123, v138, v136, v123 op_sel:[1,1,0] op_sel_hi:[1,0,1] neg_lo:[0,1,0]
    v_pk_mul_f16 v124, v139, v136 op_sel:[0,0] op_sel_hi:[0,1]
    v_pk_fma_f16 v124, v139, v136, v124 op_sel:[1,1,0] op_sel_hi:[1,0,1] neg_lo:[0,1,0]
    ds_write_addtid_b32 v148 offset:46656
    ds_write_addtid_b32 v122 offset:15456
    ds_write_addtid_b32 v123 offset:19616
    ds_write_addtid_b32 v124 offset:23776
    v_pk_mul_f16 v125, v144, v137 op_sel:[0,0] op_sel_hi:[0,1]
    v_pk_fma_f16 v125, v144, v137, v125 op_sel:[1,1,0] op_sel_hi:[1,0,1] neg_lo:[0,1,0]
    v_pk_mul_f16 v126, v144, v138 op_sel:[0,0] op_sel_hi:[0,1]
    v_pk_fma_f16 v126, v144, v138, v126 op_sel:[1,1,0] op_sel_hi:[1,0,1] neg_lo:[0,1,0]
    v_pk_mul_f16 v127, v144, v139 op_sel:[0,0] op_sel_hi:[0,1]
    v_pk_fma_f16 v127, v144, v139, v127 op_sel:[1,1,0] op_sel_hi:[1,0,1] neg_lo:[0,1,0]
    v_pk_mul_f16 v128, v144, v140 op_sel:[0,0] op_sel_hi:[0,1]
    v_pk_fma_f16 v128, v144, v140, v128 op_sel:[1,1,0] op_sel_hi:[1,0,1] neg_lo:[0,1,0]
    ds_write_addtid_b32 v125 offset:30016
    ds_write_addtid_b32 v126 offset:32096
    ds_write_addtid_b32 v127 offset:38336
    ds_write_addtid_b32 v128 offset:40416
    v_pk_mul_f16 v129, v145, v138 op_sel:[0,0] op_sel_hi:[0,1]
    v_pk_fma_f16 v129, v145, v138, v129 op_sel:[1,1,0] op_sel_hi:[1,0,1] neg_lo:[0,1,0]
    v_pk_mul_f16 v114, v146, v138 op_sel:[0,0] op_sel_hi:[0,1]
    v_pk_fma_f16 v114, v146, v138, v114 op_sel:[1,1,0] op_sel_hi:[1,0,1] neg_lo:[0,1,0]
    v_pk_mul_f16 v115, v148, v144 op_sel:[0,0] op_sel_hi:[0,1]
    v_pk_fma_f16 v115, v148, v144, v115 op_sel:[1,1,0] op_sel_hi:[1,0,1] neg_lo:[0,1,0]
    v_pk_mul_f16 v116, v148, v145 op_sel:[0,0] op_sel_hi:[0,1]
    v_pk_fma_f16 v116, v148, v145, v116 op_sel:[1,1,0] op_sel_hi:[1,0,1] neg_lo:[0,1,0]
    ds_write_addtid_b32 v129 offset:44576
    ds_write_addtid_b32 v114 offset:54976
    ds_write_addtid_b32 v115 offset:48736
    ds_write_addtid_b32 v116 offset:57056
    v_pk_mul_f16 v117, v148, v146 op_sel:[0,0] op_sel_hi:[0,1]
    v_pk_fma_f16 v117, v148, v146, v117 op_sel:[1,1,0] op_sel_hi:[1,0,1] neg_lo:[0,1,0]
    ds_write_addtid_b32 v117 offset:59136
    s_mov_b32 m0, s52
    s_nop 0
    v_cvt_pk_f16_f32 v141, v66, -v67
    v_cvt_pk_f16_f32 v142, v68, -v69
    v_cvt_pk_f16_f32 v143, v70, -v71
    v_cvt_pk_f16_f32 v150, v82, -v83
    v_pk_mul_f32 v[84:85], v[82:83], v[64:65] op_sel:[0,0] op_sel_hi:[0,1]
    v_pk_fma_f32 v[84:85], v[82:83], v[64:65], v[84:85] op_sel:[1,1,0] op_sel_hi:[1,0,1] neg_lo:[0,1,0]
    v_pk_mul_f16 v118, v150, v141 op_sel:[0,0] op_sel_hi:[0,1]
    v_pk_fma_f16 v118, v150, v141, v118 op_sel:[1,1,0] op_sel_hi:[1,0,1] neg_lo:[0,1,0]
    v_pk_mul_f16 v119, v150, v142 op_sel:[0,0] op_sel_hi:[0,1]
    v_pk_fma_f16 v119, v150, v142, v119 op_sel:[1,1,0] op_sel_hi:[1,0,1] neg_lo:[0,1,0]
    v_pk_mul_f16 v120, v150, v143 op_sel:[0,0] op_sel_hi:[0,1]
    v_pk_fma_f16 v120, v150, v143, v120 op_sel:[1,1,0] op_sel_hi:[1,0,1] neg_lo:[0,1,0]
    ds_write_addtid_b32 v150 offset:0
    ds_write_addtid_b32 v118 offset:16640
    ds_write_addtid_b32 v119 offset:33280
    ds_write_addtid_b32 v120 offset:49920
    v_cvt_pk_f16_f32 v151, v84, -v85
    v_pk_mul_f32 v[82:83], v[84:85], v[64:65] op_sel:[0,0] op_sel_hi:[0,1]
    v_pk_fma_f32 v[82:83], v[84:85], v[64:65], v[82:83] op_sel:[1,1,0] op_sel_hi:[1,0,1] neg_lo:[0,1,0]
    v_pk_mul_f16 v121, v151, v141 op_sel:[0,0] op_sel_hi:[0,1]
    v_pk_fma_f16 v121, v151, v141, v121 op_sel:[1,1,0] op_sel_hi:[1,0,1] neg_lo:[0,1,0]
    v_pk_mul_f16 v122, v151, v142 op_sel:[0,0] op_sel_hi:[0,1]
    v_pk_fma_f16 v122, v151, v142, v122 op_sel:[1,1,0] op_sel_hi:[1,0,1] neg_lo:[0,1,0]
    v_pk_mul_f16 v123, v151, v143 op_sel:[0,0] op_sel_hi:[0,1]
    v_pk_fma_f16 v123, v151, v143, v123 op_sel:[1,1,0] op_sel_hi:[1,0,1] neg_lo:[0,1,0]
    ds_write_addtid_b32 v151 offset:2080
    ds_write_addtid_b32 v121 offset:18720
    ds_write_addtid_b32 v122 offset:35360
    ds_write_addtid_b32 v123 offset:52000
    v_cvt_pk_f16_f32 v152, v82, -v83
    v_pk_mul_f32 v[84:85], v[82:83], v[64:65] op_sel:[0,0] op_sel_hi:[0,1]
    v_pk_fma_f32 v[84:85], v[82:83], v[64:65], v[84:85] op_sel:[1,1,0] op_sel_hi:[1,0,1] neg_lo:[0,1,0]
    v_pk_mul_f16 v124, v152, v141 op_sel:[0,0] op_sel_hi:[0,1]
    v_pk_fma_f16 v124, v152, v141, v124 op_sel:[1,1,0] op_sel_hi:[1,0,1] neg_lo:[0,1,0]
    v_pk_mul_f16 v125, v152, v142 op_sel:[0,0] op_sel_hi:[0,1]
    v_pk_fma_f16 v125, v152, v142, v125 op_sel:[1,1,0] op_sel_hi:[1,0,1] neg_lo:[0,1,0]
    v_pk_mul_f16 v126, v152, v143 op_sel:[0,0] op_sel_hi:[0,1]
    v_pk_fma_f16 v126, v152, v143, v126 op_sel:[1,1,0] op_sel_hi:[1,0,1] neg_lo:[0,1,0]
    ds_write_addtid_b32 v152 offset:4160
    ds_write_addtid_b32 v124 offset:20800
    ds_write_addtid_b32 v125 offset:37440
    ds_write_addtid_b32 v126 offset:54080
    v_cvt_pk_f16_f32 v153, v84, -v85
    v_pk_mul_f32 v[82:83], v[84:85], v[64:65] op_sel:[0,0] op_sel_hi:[0,1]
    v_pk_fma_f32 v[82:83], v[84:85], v[64:65], v[82:83] op_sel:[1,1,0] op_sel_hi:[1,0,1] neg_lo:[0,1,0]
    v_pk_mul_f16 v127, v153, v141 op_sel:[0,0] op_sel_hi:[0,1]
    v_pk_fma_f16 v127, v153, v141, v127 op_sel:[1,1,0] op_sel_hi:[1,0,1] neg_lo:[0,1,0]
    v_pk_mul_f16 v128, v153, v142 op_sel:[0,0] op_sel_hi:[0,1]
    v_pk_fma_f16 v128, v153, v142, v128 op_sel:[1,1,0] op_sel_hi:[1,0,1] neg_lo:[0,1,0]
    v_pk_mul_f16 v129, v153, v143 op_sel:[0,0] op_sel_hi:[0,1]
    v_pk_fma_f16 v129, v153, v143, v129 op_sel:[1,1,0] op_sel_hi:[1,0,1] neg_lo:[0,1,0]
    ds_write_addtid_b32 v153 offset:6240
    ds_write_addtid_b32 v127 offset:22880
    ds_write_addtid_b32 v128 offset:39520
    ds_write_addtid_b32 v129 offset:56160
    v_cvt_pk_f16_f32 v154, v82, -v83
    v_pk_mul_f32 v[84:85], v[82:83], v[64:65] op_sel:[0,0] op_sel_hi:[0,1]
    v_pk_fma_f32 v[84:85], v[82:83], v[64:65], v[84:85] op_sel:[1,1,0] op_sel_hi:[1,0,1] neg_lo:[0,1,0]
    v_pk_mul_f16 v114, v154, v141 op_sel:[0,0] op_sel_hi:[0,1]
    v_pk_fma_f16 v114, v154, v141, v114 op_sel:[1,1,0] op_sel_hi:[1,0,1] neg_lo:[0,1,0]
    v_pk_mul_f16 v115, v154, v142 op_sel:[0,0] op_sel_hi:[0,1]
    v_pk_fma_f16 v115, v154, v142, v115 op_sel:[1,1,0] op_sel_hi:[1,0,1] neg_lo:[0,1,0]
    v_pk_mul_f16 v116, v154, v143 op_sel:[0,0] op_sel_hi:[0,1]
    v_pk_fma_f16 v116, v154, v143, v116 op_sel:[1,1,0] op_sel_hi:[1,0,1] neg_lo:[0,1,0]
    ds_write_addtid_b32 v154 offset:8320
    ds_write_addtid_b32 v114 offset:24960
    ds_write_addtid_b32 v115 offset:41600
    ds_write_addtid_b32 v116 offset:58240
    v_cvt_pk_f16_f32 v155, v84, -v85
    v_pk_mul_f32 v[82:83], v[84:85], v[64:65] op_sel:[0,0] op_sel_hi:[0,1]
    v_pk_fma_f32 v[82:83], v[84:85], v[64:65], v[82:83] op_sel:[1,1,0] op_sel_hi:[1,0,1] neg_lo:[0,1,0]
    v_pk_mul_f16 v117, v155, v141 op_sel:[0,0] op_sel_hi:[0,1]
    v_pk_fma_f16 v117, v155, v141, v117 op_sel:[1,1,0] op_sel_hi:[1,0,1] neg_lo:[0,1,0]
    v_pk_mul_f16 v118, v155, v142 op_sel:[0,0] op_sel_hi:[0,1]
    v_pk_fma_f16 v118, v155, v142, v118 op_sel:[1,1,0] op_sel_hi:[1,0,1] neg_lo:[0,1,0]
    v_pk_mul_f16 v119, v155, v143 op_sel:[0,0] op_sel_hi:[0,1]
    v_pk_fma_f16 v119, v155, v143, v119 op_sel:[1,1,0] op_sel_hi:[1,0,1] neg_lo:[0,1,0]
    ds_write_addtid_b32 v155 offset:10400
    ds_write_addtid_b32 v117 offset:27040
    ds_write_addtid_b32 v118 offset:43680
    ds_write_addtid_b32 v119 offset:60320
    v_cvt_pk_f16_f32 v156, v82, -v83
    v_pk_mul_f32 v[84:85], v[82:83], v[64:65] op_sel:[0,0] op_sel_hi:[0,1]
    v_pk_fma_f32 v[84:85], v[82:83], v[64:65], v[84:85] op_sel:[1,1,0] op_sel_hi:[1,0,1] neg_lo:[0,1,0]
    v_pk_mul_f16 v120, v156, v141 op_sel:[0,0] op_sel_hi:[0,1]
    v_pk_fma_f16 v120, v156, v141, v120 op_sel:[1,1,0] op_sel_hi:[1,0,1] neg_lo:[0,1,0]
    v_pk_mul_f16 v121, v156, v142 op_sel:[0,0] op_sel_hi:[0,1]
    v_pk_fma_f16 v121, v156, v142, v121 op_sel:[1,1,0] op_sel_hi:[1,0,1] neg_lo:[0,1,0]
    v_pk_mul_f16 v122, v156, v143 op_sel:[0,0] op_sel_hi:[0,1]
    v_pk_fma_f16 v122, v156, v143, v122 op_sel:[1,1,0] op_sel_hi:[1,0,1] neg_lo:[0,1,0]
    ds_write_addtid_b32 v156 offset:12480
    ds_write_addtid_b32 v120 offset:29120
    ds_write_addtid_b32 v121 offset:45760
    ds_write_addtid_b32 v122 offset:62400
    v_cvt_pk_f16_f32 v157, v84, -v85
    v_pk_mul_f16 v123, v157, v141 op_sel:[0,0] op_sel_hi:[0,1]
    v_pk_fma_f16 v123, v157, v141, v123 op_sel:[1,1,0] op_sel_hi:[1,0,1] neg_lo:[0,1,0]
    v_pk_mul_f16 v124, v157, v142 op_sel:[0,0] op_sel_hi:[0,1]
    v_pk_fma_f16 v124, v157, v142, v124 op_sel:[1,1,0] op_sel_hi:[1,0,1] neg_lo:[0,1,0]
    v_pk_mul_f16 v125, v157, v143 op_sel:[0,0] op_sel_hi:[0,1]
    v_pk_fma_f16 v125, v157, v143, v125 op_sel:[1,1,0] op_sel_hi:[1,0,1] neg_lo:[0,1,0]
    ds_write_addtid_b32 v157 offset:14560
    ds_write_addtid_b32 v123 offset:31200
    ds_write_addtid_b32 v124 offset:47840
    ds_write_addtid_b32 v125 offset:64480
    ds_read_b128 v[176:179], v34 offset:0
    ds_read_b128 v[208:211], v35 offset:0
    ds_read_b128 v[180:183], v34 offset:64
    ds_read_b128 v[212:215], v35 offset:64
    ds_read_b128 v[184:187], v34 offset:128
    ds_read_b128 v[216:219], v35 offset:128
    ds_read_b128 v[188:191], v34 offset:192
    ds_read_b128 v[220:223], v35 offset:192
    ds_read_b128 v[224:227], v35 offset:33280
    ds_read_b128 v[228:231], v35 offset:33344
    ds_read_b128 v[232:235], v35 offset:33408
    ds_read_b128 v[236:239], v35 offset:33472
    ds_read_b128 v[192:195], v132 offset:18720
    ds_read_b128 v[196:199], v132 offset:18784
    ds_read_b128 v[200:203], v132 offset:18848
    ds_read_b128 v[204:207], v132 offset:18912
    s_setprio 0
    s_waitcnt lgkmcnt(14)
    v_mfma_f32_16x16x32_f16 v[40:43], v[176:179], v[208:211], v[40:43]
    s_waitcnt lgkmcnt(12)
    v_mfma_f32_16x16x32_f16 v[40:43], v[180:183], v[212:215], v[40:43]
    s_waitcnt lgkmcnt(10)
    v_mfma_f32_16x16x32_f16 v[40:43], v[184:187], v[216:219], v[40:43]
    s_waitcnt lgkmcnt(8)
    v_mfma_f32_16x16x32_f16 v[40:43], v[188:191], v[220:223], v[40:43]
    s_waitcnt lgkmcnt(7)
    v_mfma_f32_16x16x32_f16 v[44:47], v[176:179], v[224:227], v[44:47]
    s_waitcnt lgkmcnt(6)
    v_mfma_f32_16x16x32_f16 v[44:47], v[180:183], v[228:231], v[44:47]
    s_waitcnt lgkmcnt(5)
    v_mfma_f32_16x16x32_f16 v[44:47], v[184:187], v[232:235], v[44:47]
    s_waitcnt lgkmcnt(4)
    v_mfma_f32_16x16x32_f16 v[44:47], v[188:191], v[236:239], v[44:47]
    s_waitcnt lgkmcnt(3)
    v_mfma_f32_16x16x32_f16 v[52:55], v[192:195], v[224:227], v[52:55]
    s_waitcnt lgkmcnt(2)
    v_mfma_f32_16x16x32_f16 v[52:55], v[196:199], v[228:231], v[52:55]
    s_waitcnt lgkmcnt(1)
    v_mfma_f32_16x16x32_f16 v[52:55], v[200:203], v[232:235], v[52:55]
    s_waitcnt lgkmcnt(0)
    v_mfma_f32_16x16x32_f16 v[52:55], v[204:207], v[236:239], v[52:55]
    v_mfma_f32_16x16x32_f16 v[48:51], v[192:195], v[208:211], v[48:51]
    v_mfma_f32_16x16x32_f16 v[48:51], v[196:199], v[212:215], v[48:51]
    v_mfma_f32_16x16x32_f16 v[48:51], v[200:203], v[216:219], v[48:51]
    v_mfma_f32_16x16x32_f16 v[48:51], v[204:207], v[220:223], v[48:51]
    v_permlane16_swap_b32 v40, v44
    v_permlane16_swap_b32 v41, v45
    v_permlane16_swap_b32 v42, v46
    v_permlane16_swap_b32 v43, v47
    s_nop 3
    v_permlane16_swap_b32 v48, v52
    v_permlane16_swap_b32 v49, v53
    v_permlane16_swap_b32 v50, v54
    v_permlane16_swap_b32 v51, v55
    v_pk_mul_f32 v[40:41], v[40:41], v[134:135] op_sel_hi:[1,0]
    v_pk_mul_f32 v[42:43], v[42:43], v[134:135] op_sel_hi:[1,0]
    v_pk_mul_f32 v[44:45], v[44:45], v[134:135] op_sel_hi:[1,0]
    v_pk_mul_f32 v[46:47], v[46:47], v[134:135] op_sel_hi:[1,0]
    v_pk_mul_f32 v[48:49], v[48:49], v[134:135] op_sel_hi:[1,0]
    v_pk_mul_f32 v[50:51], v[50:51], v[134:135] op_sel_hi:[1,0]
    v_pk_mul_f32 v[52:53], v[52:53], v[134:135] op_sel_hi:[1,0]
    s_mul_i32 s64, s3, 4640
    s_add_u32 s64, s64, 119088
    v_mov_b32_e64 v36, 0
    v_writelane_b32 v36, s45, 0
    v_add_f32_e64 v40, v40, v36
    v_mov_b32_dpp v37, v47 wave_shr:1 row_mask:0xf bank_mask:0xf bound_ctrl:1
    v_cvt_pk_bf16_f32 v56, v41, v40
    v_cvt_pk_bf16_f32 v60, v40, v37
    v_cvt_pk_bf16_f32 v57, v43, v42
    v_cvt_pk_bf16_f32 v61, v42, v41
    v_cvt_pk_bf16_f32 v58, v45, v44
    v_cvt_pk_bf16_f32 v62, v44, v43
    v_cvt_pk_bf16_f32 v59, v47, v46
    v_cvt_pk_bf16_f32 v63, v46, v45
    v_cvt_pk_bf16_f32 v64, v49, v48
    v_cvt_pk_bf16_f32 v65, v50, v51
    v_cvt_pk_bf16_f32 v66, v52, v52
    v_mov_b32 v67, 0x0c0c0c0c
    v_readfirstlane_b32 s65, v64
    v_readfirstlane_b32 s66, v66
    s_mov_b32 s42, 0x3020302
    v_writelane_b32 v67, s42, 16
    s_mov_b32 s42, 0x3020100
    v_writelane_b32 v67, s42, 17
    s_mov_b32 s42, 0x1000100
    v_writelane_b32 v67, s42, 18
    s_mov_b32 s42, 0x3020302
    v_writelane_b32 v67, s42, 48
    s_mov_b32 s42, 0x3020302
    v_writelane_b32 v67, s42, 49
    s_mov_b32 s42, 0x1000100
    v_writelane_b32 v67, s42, 50
    s_mov_b32 s42, 0x1000c0c
    v_writelane_b32 v67, s42, 51
    v_writelane_b32 v64, 0, 0
    v_perm_b32 v67, s65, s65, v67
    v_lshl_add_u32 v68, v1, 4, s64
    v_mov_b32 v72, 0
    v_mov_b32 v73, 0
    v_mov_b32 v74, 0
    v_mov_b32 v75, 0
    v_lshl_add_u32 v69, v1, 2, s64
    v_bfe_u32 v70, v1, 4, 1
    v_lshl_add_u32 v70, v70, 10, v69
    v_lshrrev_b32_e64 v71, 5, v1
    v_mov_b32 v76, 1088
    v_mad_u32_u24 v70, v71, v76, v70
    v_lshl_add_u32 v76, v71, 5, v1
    v_and_b32 v77, 1, v1
    v_lshlrev_b32 v76, 1, v76
    v_lshlrev_b32 v77, 2, v77
    v_sub_u32 v76, v76, v77
    s_add_u32 s42, s64, 3022
    v_add_u32_e64 v76, s42, v76
    ds_write_b128 v68, v[72:75] offset:2432
    ds_write_b128 v68, v[56:59] offset:64
    ds_write_b128 v68, v[60:63] offset:1280
    ds_write_b32 v70, v67
    ds_write_b32 v69, v64 offset:2560
    ds_write_b16 v76, v65
    ds_write_b16_d16_hi v76, v65 offset:64
    v_add_u32 v8, 5, v32
    v_lshrrev_b32 v8, 1, v8
    v_lshlrev_b32 v9, 2, v33
    v_sub_u32 v8, v8, v9
    v_add_u32 v8, 13, v8
    v_and_b32 v10, 1, v32
    v_mul_u32_u24 v10, 1216, v10
    v_lshl_add_u32 v2, v8, 2, v10
    v_add_u32_e64 v2, s64, v2
    v_add_u32 v3, 1024, v2
    s_mul_i32 s42, s3, 4640
    s_add_u32 s42, s42, 118560
    v_lshl_add_u32 v8, v32, 1, v33
    v_lshl_add_u32 v4, v8, 4, s42
    v_sub_u32_e64 v8, v32, v9
    s_add_u32 s42, s64, 2540
    v_lshl_add_u32 v5, v8, 3, s42
    s_add_u32 s42, s64, 3008
    v_lshl_add_u32 v6, v8, 2, s42
    v_lshlrev_b32_e64 v7, 4, v1
    v_add_u32 v7, 155680, v7
    s_lshl_b32 s42, s3, 13
    v_lshl_add_u32 v68, v1, 3, s42
    v_lshlrev_b32 v69, 3, v0
    v_lshl_add_u32 v70, v32, 2, v33
    s_lshl_b32 s42, s3, 6
    v_add_u32 v70, s42, v70
    v_mul_u32_u24 v70, 10240, v70
    s_lshl_b32 s42, s6, 4
    s_add_u32 s42, s42, 3840
    v_add_u32 v70, s42, v70
    v_add_u32 v71, 5120, v70
    ds_read2_b32 v[72:73], v2 offset0:115 offset1:114
    ds_read2_b32 v[74:75], v2 offset0:113 offset1:112
    ds_read2_b32 v[76:77], v2 offset0:99 offset1:98
    ds_read2_b32 v[78:79], v2 offset0:97 offset1:96
    ds_read2_b32 v[80:81], v2 offset0:83 offset1:82
    ds_read2_b32 v[82:83], v2 offset0:81 offset1:80
    ds_read2_b32 v[84:85], v2 offset0:67 offset1:66
    ds_read2_b32 v[86:87], v2 offset0:65 offset1:64
    ds_read2_b32 v[88:89], v2 offset0:51 offset1:50
    ds_read2_b32 v[90:91], v2 offset0:49 offset1:48
    ds_read2_b32 v[92:93], v2 offset0:35 offset1:34
    ds_read2_b32 v[94:95], v2 offset0:33 offset1:32
    ds_read2_b32 v[96:97], v2 offset0:19 offset1:18
    ds_read2_b32 v[98:99], v2 offset0:17 offset1:16
    ds_read2_b32 v[100:101], v2 offset0:131 offset1:130
    ds_read2_b32 v[102:103], v2 offset0:129 offset1:128
    ds_read2_b32 v[104:105], v2 offset0:3 offset1:2
    ds_read2_b32 v[106:107], v2 offset0:1 offset1:0
    ds_read2_b32 v[108:109], v5 offset0:7 offset1:6
    ds_read2_b32 v[110:111], v5 offset0:5 offset1:4
    ds_read2_b32 v[112:113], v5 offset0:3 offset1:2
    ds_read2_b32 v[114:115], v5 offset0:1 offset1:0
    ds_read2_b32 v[116:117], v5 offset0:39 offset1:38
    ds_read2_b32 v[118:119], v5 offset0:37 offset1:36
    ds_read2_b32 v[120:121], v5 offset0:35 offset1:34
    ds_read2_b32 v[122:123], v5 offset0:33 offset1:32
    ds_read2_b32 v[124:125], v5 offset0:71 offset1:70
    ds_read2_b32 v[126:127], v5 offset0:69 offset1:68
    ds_read2_b32 v[128:129], v5 offset0:67 offset1:66
    ds_read2_b32 v[130:131], v5 offset0:65 offset1:64
    ds_read2_b32 v[132:133], v6 offset0:3 offset1:2
    ds_read2_b32 v[134:135], v6 offset0:1 offset1:0
    ds_read2_b32 v[136:137], v6 offset0:19 offset1:18
    ds_read2_b32 v[138:139], v6 offset0:17 offset1:16
    ds_read2_b32 v[140:141], v6 offset0:35 offset1:34
    ds_read2_b32 v[142:143], v6 offset0:33 offset1:32
    ds_read2_b32 v[144:145], v6 offset0:51 offset1:50
    ds_read2_b32 v[146:147], v6 offset0:49 offset1:48
    ds_read2_b32 v[148:149], v2 offset0:243 offset1:242
    ds_read2_b32 v[150:151], v2 offset0:241 offset1:240
    ds_read2_b32 v[152:153], v2 offset0:227 offset1:226
    ds_read2_b32 v[154:155], v2 offset0:225 offset1:224
    ds_read2_b32 v[156:157], v2 offset0:211 offset1:210
    ds_read2_b32 v[158:159], v2 offset0:209 offset1:208
    ds_read2_b32 v[160:161], v2 offset0:195 offset1:194
    ds_read2_b32 v[162:163], v2 offset0:193 offset1:192
    ds_read2_b32 v[164:165], v2 offset0:179 offset1:178
    ds_read2_b32 v[166:167], v2 offset0:177 offset1:176
    ds_read2_b32 v[168:169], v2 offset0:163 offset1:162
    ds_read2_b32 v[170:171], v2 offset0:161 offset1:160
    ds_read2_b32 v[172:173], v2 offset0:147 offset1:146
    ds_read2_b32 v[174:175], v2 offset0:145 offset1:144
    ds_read2_b32 v[176:177], v3 offset0:3 offset1:2
    ds_read2_b32 v[178:179], v3 offset0:1 offset1:0
    s_waitcnt lgkmcnt(0)
    s_barrier
    buffer_load_dwordx4 v[16:19], v14, s[48:51], s47 offen
    buffer_load_dwordx4 v[20:23], v15, s[48:51], s47 offen
    ds_read_b128 v[180:183], v7 offset:0
    ds_read_b128 v[184:187], v7 offset:1024
    ds_read_b128 v[188:191], v7 offset:2048
    ds_read_b128 v[192:195], v7 offset:3072
    ds_read_b128 v[196:199], v7 offset:4096
    ds_read_b128 v[200:203], v7 offset:5120
    s_mov_b32 s62, 0x05040100
    s_mov_b32 s63, 0x07060302
    v_lshlrev_b32_e64 v2, 2, v0
    v_add_u32 v2, 119080, v2
    s_waitcnt vmcnt(0)
    s_nop 0
    v_perm_b32 v40, v20, v16, s62
    v_perm_b32 v41, v20, v16, s63
    v_perm_b32 v42, v21, v17, s62
    v_perm_b32 v43, v21, v17, s63
    v_perm_b32 v44, v22, v18, s62
    v_perm_b32 v45, v22, v18, s63
    v_perm_b32 v46, v23, v19, s62
    v_perm_b32 v47, v23, v19, s63
    ds_write_b32 v2, v40 offset:0
    ds_write_b32 v2, v41 offset:4640
    ds_write_b32 v2, v42 offset:9280
    ds_write_b32 v2, v43 offset:13920
    ds_write_b32 v2, v44 offset:18560
    ds_write_b32 v2, v45 offset:23200
    ds_write_b32 v2, v46 offset:27840
    ds_write_b32 v2, v47 offset:32480
    s_waitcnt lgkmcnt(0)
    s_barrier
    s_add_u32 s47, s47, 1309440
    buffer_load_dwordx4 v[248:251], v15, s[48:51], s47 offen
    buffer_load_dwordx4 v[252:255], v15, s[48:51], s47 offen offset:1280
    s_setprio 3
    ds_read_b128 v[204:207], v4 offset:480
    s_waitcnt lgkmcnt(0)
    v_mfma_f32_16x16x32_bf16 v[40:43], v[204:207], v[180:183], 0
    ds_read_b128 v[208:211], v4 offset:64
    ds_read_b128 v[212:215], v4 offset:128
    v_mfma_f32_16x16x32_bf16 v[44:47], v[204:207], v[184:187], 0
    ds_read_b128 v[216:219], v4 offset:192
    ds_read_b128 v[220:223], v4 offset:256
    v_mfma_f32_16x16x32_bf16 v[48:51], v[204:207], v[188:191], 0
    ds_read_b128 v[224:227], v4 offset:320
    ds_read_b128 v[228:231], v4 offset:384
    v_mfma_f32_16x16x32_bf16 v[52:55], v[204:207], v[192:195], 0
    ds_read_b128 v[232:235], v4 offset:448
    s_waitcnt lgkmcnt(6)
    v_mfma_f32_16x16x32_bf16 v[8:11], v[72:75], v[208:211], 0
    ds_read_b128 v[236:239], v4 offset:0
    s_waitcnt lgkmcnt(6)
    v_mfma_f32_16x16x32_bf16 v[8:11], v[76:79], v[212:215], v[8:11]
    ds_read_b128 v[240:243], v4 offset:512
    s_waitcnt lgkmcnt(6)
    v_mfma_f32_16x16x32_bf16 v[8:11], v[80:83], v[216:219], v[8:11]
    s_waitcnt lgkmcnt(5)
    v_mfma_f32_16x16x32_bf16 v[8:11], v[84:87], v[220:223], v[8:11]
    v_cvt_pk_bf16_f32 v56, v40, v44
    v_cvt_pk_bf16_f32 v57, v48, v52
    s_waitcnt lgkmcnt(3)
    v_mfma_f32_16x16x32_bf16 v[8:11], v[88:91], v[224:227], v[8:11]
    v_cvt_pk_bf16_f32 v58, v41, v45
    v_cvt_pk_bf16_f32 v59, v49, v53
    v_mfma_f32_16x16x32_bf16 v[8:11], v[92:95], v[228:231], v[8:11]
    v_cvt_pk_bf16_f32 v60, v42, v46
    v_cvt_pk_bf16_f32 v61, v50, v54
    s_waitcnt lgkmcnt(1)
    v_mfma_f32_16x16x32_bf16 v[8:11], v[96:99], v[232:235], v[8:11]
    v_cvt_pk_bf16_f32 v62, v43, v47
    v_cvt_pk_bf16_f32 v63, v51, v55
    v_mfma_f32_16x16x32_bf16 v[8:11], v[100:103], v[236:239], v[8:11]
    s_waitcnt lgkmcnt(0)
    v_mfma_f32_16x16x32_bf16 v[8:11], v[104:107], v[240:243], v[8:11]
    v_mfma_f32_16x16x32_bf16 v[40:43], v[204:207], v[196:199], 0
    v_mfma_f32_16x16x32_bf16 v[44:47], v[204:207], v[200:203], 0
    v_mfma_f32_16x16x32_bf16 v[16:19], v[56:59], v[108:111], 0
    v_mfma_f32_16x16x32_bf16 v[16:19], v[60:63], v[112:115], v[16:19]
    v_mfma_f32_16x16x32_bf16 v[20:23], v[56:59], v[116:119], 0
    v_mfma_f32_16x16x32_bf16 v[20:23], v[60:63], v[120:123], v[20:23]
    s_nop 3
    v_cvt_pk_bf16_f32 v64, v40, v44
    v_cvt_pk_bf16_f32 v65, v41, v45
    ds_read_b128 v[244:247], v4 offset:992
    v_mfma_f32_16x16x32_bf16 v[24:27], v[56:59], v[124:127], 0
    v_cvt_pk_bf16_f32 v66, v42, v46
    v_cvt_pk_bf16_f32 v67, v43, v47
    v_mfma_f32_16x16x32_bf16 v[24:27], v[60:63], v[128:131], v[24:27]
    s_nop 0
    v_mfma_f32_16x16x32_bf16 v[24:27], v[64:67], v[132:135], v[24:27]
    v_cvt_pk_bf16_f32 v8, v8, v9
    v_mfma_f32_16x16x32_bf16 v[28:31], v[64:67], v[136:139], 0
    v_cvt_pk_bf16_f32 v9, v10, v11
    v_mfma_f32_16x16x32_bf16 v[32:35], v[64:67], v[140:143], 0
    ds_write_b64 v68, v[8:9] offset:3456
    ds_read_b128 v[204:207], v4 offset:576
    v_mfma_f32_16x16x32_bf16 v[36:39], v[64:67], v[144:147], 0
    s_waitcnt lgkmcnt(2)
    v_mfma_f32_16x16x32_bf16 v[40:43], v[244:247], v[180:183], 0
    ds_read_b128 v[144:147], v4 offset:640
    v_mfma_f32_16x16x32_bf16 v[44:47], v[244:247], v[184:187], 0
    v_mfma_f32_16x16x32_bf16 v[48:51], v[244:247], v[188:191], 0
    v_mfma_f32_16x16x32_bf16 v[52:55], v[244:247], v[192:195], 0
    v_mfma_f32_16x16x32_bf16 v[12:15], v[148:151], v[208:211], 0
    ds_read_b128 v[208:211], v4 offset:704
    s_waitcnt lgkmcnt(2)
    v_mfma_f32_16x16x32_bf16 v[12:15], v[72:75], v[204:207], v[12:15]
    v_mfma_f32_16x16x32_bf16 v[12:15], v[152:155], v[212:215], v[12:15]
    ds_read_b128 v[212:215], v4 offset:768
    s_waitcnt lgkmcnt(2)
    v_mfma_f32_16x16x32_bf16 v[12:15], v[76:79], v[144:147], v[12:15]
    v_mfma_f32_16x16x32_bf16 v[12:15], v[156:159], v[216:219], v[12:15]
    v_cvt_pk_bf16_f32 v56, v40, v44
    ds_read_b128 v[216:219], v4 offset:832
    s_waitcnt lgkmcnt(2)
    v_mfma_f32_16x16x32_bf16 v[12:15], v[80:83], v[208:211], v[12:15]
    v_cvt_pk_bf16_f32 v57, v48, v52
    v_mfma_f32_16x16x32_bf16 v[12:15], v[160:163], v[220:223], v[12:15]
    v_cvt_pk_bf16_f32 v58, v41, v45
    ds_read_b128 v[220:223], v4 offset:896
    s_waitcnt lgkmcnt(2)
    v_mfma_f32_16x16x32_bf16 v[12:15], v[84:87], v[212:215], v[12:15]
    v_cvt_pk_bf16_f32 v59, v49, v53
    v_mfma_f32_16x16x32_bf16 v[12:15], v[164:167], v[224:227], v[12:15]
    v_cvt_pk_bf16_f32 v60, v42, v46
    ds_read_b128 v[224:227], v4 offset:960
    s_waitcnt lgkmcnt(2)
    v_mfma_f32_16x16x32_bf16 v[12:15], v[88:91], v[216:219], v[12:15]
    v_cvt_pk_bf16_f32 v61, v50, v54
    s_setprio 2
    v_mfma_f32_16x16x32_bf16 v[12:15], v[168:171], v[228:231], v[12:15]
    v_cvt_pk_bf16_f32 v62, v43, v47
    ds_read_b128 v[228:231], v4 offset:1024
    s_waitcnt lgkmcnt(2)
    v_mfma_f32_16x16x32_bf16 v[12:15], v[92:95], v[220:223], v[12:15]
    v_cvt_pk_bf16_f32 v63, v51, v55
    v_mfma_f32_16x16x32_bf16 v[12:15], v[172:175], v[232:235], v[12:15]
    s_waitcnt lgkmcnt(1)
    v_mfma_f32_16x16x32_bf16 v[12:15], v[96:99], v[224:227], v[12:15]
    v_mfma_f32_16x16x32_bf16 v[12:15], v[176:179], v[236:239], v[12:15]
    v_mfma_f32_16x16x32_bf16 v[12:15], v[100:103], v[240:243], v[12:15]
    s_waitcnt lgkmcnt(0)
    v_mfma_f32_16x16x32_bf16 v[12:15], v[104:107], v[228:231], v[12:15]
    v_mfma_f32_16x16x32_bf16 v[40:43], v[244:247], v[196:199], 0
    v_mfma_f32_16x16x32_bf16 v[44:47], v[244:247], v[200:203], 0
    v_mfma_f32_16x16x32_bf16 v[20:23], v[56:59], v[108:111], v[20:23]
    v_mfma_f32_16x16x32_bf16 v[20:23], v[60:63], v[112:115], v[20:23]
    v_mfma_f32_16x16x32_bf16 v[24:27], v[56:59], v[116:119], v[24:27]
    ds_read_b128 v[232:235], v4 offset:1504
    v_mfma_f32_16x16x32_bf16 v[24:27], v[60:63], v[120:123], v[24:27]
    s_nop 2
    v_cvt_pk_bf16_f32 v64, v40, v44
    v_cvt_pk_bf16_f32 v65, v41, v45
    v_mfma_f32_16x16x32_bf16 v[28:31], v[56:59], v[124:127], v[28:31]
    v_cvt_pk_bf16_f32 v66, v42, v46
    v_cvt_pk_bf16_f32 v67, v43, v47
    v_mfma_f32_16x16x32_bf16 v[28:31], v[60:63], v[128:131], v[28:31]
    s_nop 0
    v_mfma_f32_16x16x32_bf16 v[28:31], v[64:67], v[132:135], v[28:31]
    v_cvt_pk_bf16_f32 v12, v12, v13
    v_mfma_f32_16x16x32_bf16 v[32:35], v[64:67], v[136:139], v[32:35]
    v_cvt_pk_bf16_f32 v13, v14, v15
    ds_read_b128 v[236:239], v4 offset:1088
    v_mfma_f32_16x16x32_bf16 v[36:39], v[64:67], v[140:143], v[36:39]
    ds_write_b64 v68, v[12:13] offset:3968
    s_waitcnt lgkmcnt(2)
    v_mfma_f32_16x16x32_bf16 v[40:43], v[232:235], v[180:183], 0
    ds_read_b128 v[244:247], v4 offset:1152
    v_mfma_f32_16x16x32_bf16 v[44:47], v[232:235], v[184:187], 0
    v_mfma_f32_16x16x32_bf16 v[48:51], v[232:235], v[188:191], 0
    ds_read_b128 v[140:143], v4 offset:1216
    v_mfma_f32_16x16x32_bf16 v[52:55], v[232:235], v[192:195], 0
    v_mfma_f32_16x16x32_bf16 v[16:19], v[148:151], v[204:207], v[16:19]
    ds_read_b128 v[12:15], v4 offset:1280
    s_waitcnt lgkmcnt(3)
    v_mfma_f32_16x16x32_bf16 v[16:19], v[72:75], v[236:239], v[16:19]
    v_mfma_f32_16x16x32_bf16 v[16:19], v[152:155], v[144:147], v[16:19]
    ds_read_b128 v[204:207], v4 offset:1344
    s_waitcnt lgkmcnt(3)
    v_mfma_f32_16x16x32_bf16 v[16:19], v[76:79], v[244:247], v[16:19]
    v_mfma_f32_16x16x32_bf16 v[16:19], v[156:159], v[208:211], v[16:19]
    v_cvt_pk_bf16_f32 v56, v40, v44
    s_setprio 1
    ds_read_b128 v[144:147], v4 offset:1408
    s_waitcnt lgkmcnt(3)
    v_mfma_f32_16x16x32_bf16 v[16:19], v[80:83], v[140:143], v[16:19]
    v_cvt_pk_bf16_f32 v57, v48, v52
    v_mfma_f32_16x16x32_bf16 v[16:19], v[160:163], v[212:215], v[16:19]
    v_cvt_pk_bf16_f32 v58, v41, v45
    ds_read_b128 v[208:211], v4 offset:1472
    s_waitcnt lgkmcnt(3)
    v_mfma_f32_16x16x32_bf16 v[16:19], v[84:87], v[12:15], v[16:19]
    v_cvt_pk_bf16_f32 v59, v49, v53
    v_mfma_f32_16x16x32_bf16 v[16:19], v[164:167], v[216:219], v[16:19]
    v_cvt_pk_bf16_f32 v60, v42, v46
    s_waitcnt lgkmcnt(2)
    v_mfma_f32_16x16x32_bf16 v[16:19], v[88:91], v[204:207], v[16:19]
    v_cvt_pk_bf16_f32 v61, v50, v54
    ds_read_b128 v[212:215], v4 offset:1536
    v_mfma_f32_16x16x32_bf16 v[16:19], v[168:171], v[220:223], v[16:19]
    v_cvt_pk_bf16_f32 v62, v43, v47
    s_waitcnt lgkmcnt(2)
    v_mfma_f32_16x16x32_bf16 v[16:19], v[92:95], v[144:147], v[16:19]
    v_cvt_pk_bf16_f32 v63, v51, v55
    v_mfma_f32_16x16x32_bf16 v[16:19], v[172:175], v[224:227], v[16:19]
    s_waitcnt lgkmcnt(1)
    v_mfma_f32_16x16x32_bf16 v[16:19], v[96:99], v[208:211], v[16:19]
    v_mfma_f32_16x16x32_bf16 v[16:19], v[176:179], v[240:243], v[16:19]
    v_mfma_f32_16x16x32_bf16 v[16:19], v[100:103], v[228:231], v[16:19]
    s_waitcnt lgkmcnt(0)
    v_mfma_f32_16x16x32_bf16 v[16:19], v[104:107], v[212:215], v[16:19]
    v_mfma_f32_16x16x32_bf16 v[40:43], v[232:235], v[196:199], 0
    v_mfma_f32_16x16x32_bf16 v[44:47], v[232:235], v[200:203], 0
    s_setprio 0
    ds_read_b128 v[216:219], v7 offset:6144
    v_mfma_f32_16x16x32_bf16 v[24:27], v[56:59], v[108:111], v[24:27]
    v_mfma_f32_16x16x32_bf16 v[24:27], v[60:63], v[112:115], v[24:27]
    ds_read_b128 v[220:223], v4 offset:2016
    v_mfma_f32_16x16x32_bf16 v[28:31], v[56:59], v[116:119], v[28:31]
    v_mfma_f32_16x16x32_bf16 v[28:31], v[60:63], v[120:123], v[28:31]
    s_nop 0
    v_cvt_pk_bf16_f32 v64, v40, v44
    v_cvt_pk_bf16_f32 v65, v41, v45
    v_mfma_f32_16x16x32_bf16 v[32:35], v[56:59], v[124:127], v[32:35]
    v_cvt_pk_bf16_f32 v66, v42, v46
    v_cvt_pk_bf16_f32 v67, v43, v47
    v_mfma_f32_16x16x32_bf16 v[32:35], v[60:63], v[128:131], v[32:35]
    s_waitcnt lgkmcnt(1)
    v_and_b32 v8, s66, v216
    v_and_b32 v9, s66, v217
    v_and_b32 v10, s66, v218
    v_and_b32 v11, s66, v219
    v_mfma_f32_16x16x32_bf16 v[32:35], v[64:67], v[132:135], v[32:35]
    v_cvt_pk_bf16_f32 v16, v16, v17
    ds_read_b128 v[224:227], v4 offset:1600
    v_mfma_f32_16x16x32_bf16 v[36:39], v[64:67], v[136:139], v[36:39]
    v_cvt_pk_bf16_f32 v17, v18, v19
    ds_write_b64 v68, v[16:17] offset:4480
    s_waitcnt vmcnt(0)
    s_nop 0
    v_perm_b32 v40, v252, v248, s62
    v_perm_b32 v41, v252, v248, s63
    v_perm_b32 v42, v253, v249, s62
    v_perm_b32 v43, v253, v249, s63
    v_perm_b32 v44, v254, v250, s62
    v_perm_b32 v45, v254, v250, s63
    v_perm_b32 v46, v255, v251, s62
    v_perm_b32 v47, v255, v251, s63
    ds_write_b32 v2, v40 offset:2048
    ds_write_b32 v2, v41 offset:6688
    ds_write_b32 v2, v42 offset:11328
    ds_write_b32 v2, v43 offset:15968
    ds_write_b32 v2, v44 offset:20608
    ds_write_b32 v2, v45 offset:25248
    ds_write_b32 v2, v46 offset:29888
    ds_write_b32 v2, v47 offset:34528
    s_waitcnt lgkmcnt(0)
    s_barrier
    s_sub_u32 s42, s3, 0
    s_cmp_le_u32 s42, 2
    s_cbranch_scc1 L_b_out2
L_b_back2:
    s_setprio 3
    v_mfma_f32_16x16x32_bf16 v[40:43], v[220:223], v[180:183], 0
    ds_read_b128 v[240:243], v4 offset:1664
    v_mfma_f32_16x16x32_bf16 v[44:47], v[220:223], v[184:187], 0
    v_mfma_f32_16x16x32_bf16 v[48:51], v[220:223], v[188:191], 0
    ds_read_b128 v[232:235], v4 offset:1728
    v_mfma_f32_16x16x32_bf16 v[52:55], v[220:223], v[192:195], 0
    v_mfma_f32_16x16x32_bf16 v[20:23], v[148:151], v[236:239], v[20:23]
    ds_read_b128 v[216:219], v4 offset:1792
    v_mfma_f32_16x16x32_bf16 v[20:23], v[72:75], v[224:227], v[20:23]
    v_mfma_f32_16x16x32_bf16 v[20:23], v[152:155], v[244:247], v[20:23]
    ds_read_b128 v[136:139], v4 offset:1856
    s_waitcnt lgkmcnt(3)
    v_mfma_f32_16x16x32_bf16 v[20:23], v[76:79], v[240:243], v[20:23]
    v_mfma_f32_16x16x32_bf16 v[20:23], v[156:159], v[140:143], v[20:23]
    v_cvt_pk_bf16_f32 v56, v40, v44
    ds_read_b128 v[16:19], v4 offset:1920
    s_waitcnt lgkmcnt(3)
    v_mfma_f32_16x16x32_bf16 v[20:23], v[80:83], v[232:235], v[20:23]
    v_cvt_pk_bf16_f32 v57, v48, v52
    v_mfma_f32_16x16x32_bf16 v[20:23], v[160:163], v[12:15], v[20:23]
    v_cvt_pk_bf16_f32 v58, v41, v45
    ds_read_b128 v[248:251], v4 offset:1984
    s_waitcnt lgkmcnt(3)
    v_mfma_f32_16x16x32_bf16 v[20:23], v[84:87], v[216:219], v[20:23]
    v_cvt_pk_bf16_f32 v59, v49, v53
    ds_read_b128 v[252:255], v4 offset:0
    v_mfma_f32_16x16x32_bf16 v[20:23], v[164:167], v[204:207], v[20:23]
    v_cvt_pk_bf16_f32 v60, v42, v46
    s_waitcnt lgkmcnt(3)
    v_mfma_f32_16x16x32_bf16 v[20:23], v[88:91], v[136:139], v[20:23]
    v_cvt_pk_bf16_f32 v61, v50, v54
    v_mfma_f32_16x16x32_bf16 v[20:23], v[168:171], v[144:147], v[20:23]
    v_cvt_pk_bf16_f32 v62, v43, v47
    ds_read_b128 v[236:239], v4 offset:2048
    s_waitcnt lgkmcnt(3)
    v_mfma_f32_16x16x32_bf16 v[20:23], v[92:95], v[16:19], v[20:23]
    v_cvt_pk_bf16_f32 v63, v51, v55
    v_mfma_f32_16x16x32_bf16 v[20:23], v[172:175], v[208:211], v[20:23]
    s_waitcnt lgkmcnt(1)
    v_mfma_f32_16x16x32_bf16 v[20:23], v[96:99], v[248:251], v[20:23]
    v_mfma_f32_16x16x32_bf16 v[20:23], v[8:11], v[252:255], v[20:23]
    v_mfma_f32_16x16x32_bf16 v[20:23], v[176:179], v[228:231], v[20:23]
    v_mfma_f32_16x16x32_bf16 v[20:23], v[100:103], v[212:215], v[20:23]
    s_waitcnt lgkmcnt(0)
    v_mfma_f32_16x16x32_bf16 v[20:23], v[104:107], v[236:239], v[20:23]
    v_mfma_f32_16x16x32_bf16 v[40:43], v[220:223], v[196:199], 0
    v_mfma_f32_16x16x32_bf16 v[44:47], v[220:223], v[200:203], 0
    v_mfma_f32_16x16x32_bf16 v[28:31], v[56:59], v[108:111], v[28:31]
    s_setprio 2
    ds_read_b128 v[244:247], v4 offset:2528
    v_mfma_f32_16x16x32_bf16 v[28:31], v[60:63], v[112:115], v[28:31]
    v_mfma_f32_16x16x32_bf16 v[32:35], v[56:59], v[116:119], v[32:35]
    v_mfma_f32_16x16x32_bf16 v[32:35], v[60:63], v[120:123], v[32:35]
    s_nop 1
    v_cvt_pk_bf16_f32 v64, v40, v44
    v_cvt_pk_bf16_f32 v65, v41, v45
    v_mfma_f32_16x16x32_bf16 v[36:39], v[56:59], v[124:127], v[36:39]
    v_cvt_pk_bf16_f32 v66, v42, v46
    v_cvt_pk_bf16_f32 v67, v43, v47
    v_mfma_f32_16x16x32_bf16 v[36:39], v[60:63], v[128:131], v[36:39]
    ds_read_b128 v[140:143], v4 offset:2112
    v_mfma_f32_16x16x32_bf16 v[36:39], v[64:67], v[132:135], v[36:39]
    v_cvt_pk_bf16_f32 v20, v20, v21
    v_cvt_pk_bf16_f32 v21, v22, v23
    ds_write_b64 v68, v[20:21] offset:4992
    s_waitcnt lgkmcnt(2)
    v_mfma_f32_16x16x32_bf16 v[40:43], v[244:247], v[180:183], 0
    ds_read_b128 v[12:15], v4 offset:2176
    v_mfma_f32_16x16x32_bf16 v[44:47], v[244:247], v[184:187], 0
    v_mfma_f32_16x16x32_bf16 v[48:51], v[244:247], v[188:191], 0
    ds_read_b128 v[204:207], v4 offset:2240
    v_mfma_f32_16x16x32_bf16 v[52:55], v[244:247], v[192:195], 0
    v_mfma_f32_16x16x32_bf16 v[24:27], v[148:151], v[224:227], v[24:27]
    ds_read_b128 v[144:147], v4 offset:2304
    s_waitcnt lgkmcnt(3)
    v_mfma_f32_16x16x32_bf16 v[24:27], v[72:75], v[140:143], v[24:27]
    v_mfma_f32_16x16x32_bf16 v[24:27], v[152:155], v[240:243], v[24:27]
    ds_read_b128 v[208:211], v4 offset:2368
    s_waitcnt lgkmcnt(3)
    v_mfma_f32_16x16x32_bf16 v[24:27], v[76:79], v[12:15], v[24:27]
    v_mfma_f32_16x16x32_bf16 v[24:27], v[156:159], v[232:235], v[24:27]
    v_cvt_pk_bf16_f32 v56, v40, v44
    ds_read_b128 v[252:255], v4 offset:2432
    s_waitcnt lgkmcnt(3)
    v_mfma_f32_16x16x32_bf16 v[24:27], v[80:83], v[204:207], v[24:27]
    v_cvt_pk_bf16_f32 v57, v48, v52
    v_mfma_f32_16x16x32_bf16 v[24:27], v[160:163], v[216:219], v[24:27]
    v_cvt_pk_bf16_f32 v58, v41, v45
    s_setprio 1
    ds_read_b128 v[228:231], v4 offset:2496
    s_waitcnt lgkmcnt(3)
    v_mfma_f32_16x16x32_bf16 v[24:27], v[84:87], v[144:147], v[24:27]
    v_cvt_pk_bf16_f32 v59, v49, v53
    ds_read_b128 v[196:199], v4 offset:512
    v_mfma_f32_16x16x32_bf16 v[24:27], v[164:167], v[136:139], v[24:27]
    v_cvt_pk_bf16_f32 v60, v42, v46
    s_waitcnt lgkmcnt(3)
    v_mfma_f32_16x16x32_bf16 v[24:27], v[88:91], v[208:211], v[24:27]
    v_cvt_pk_bf16_f32 v61, v50, v54
    v_mfma_f32_16x16x32_bf16 v[24:27], v[168:171], v[16:19], v[24:27]
    v_cvt_pk_bf16_f32 v62, v43, v47
    ds_read_b128 v[200:203], v4 offset:2560
    s_waitcnt lgkmcnt(3)
    v_mfma_f32_16x16x32_bf16 v[24:27], v[92:95], v[252:255], v[24:27]
    v_cvt_pk_bf16_f32 v63, v51, v55
    v_mfma_f32_16x16x32_bf16 v[24:27], v[172:175], v[248:251], v[24:27]
    s_waitcnt lgkmcnt(1)
    v_mfma_f32_16x16x32_bf16 v[24:27], v[96:99], v[228:231], v[24:27]
    v_mfma_f32_16x16x32_bf16 v[24:27], v[8:11], v[196:199], v[24:27]
    v_mfma_f32_16x16x32_bf16 v[24:27], v[176:179], v[212:215], v[24:27]
    ds_read_b128 v[220:223], v4 offset:3040
    v_mfma_f32_16x16x32_bf16 v[24:27], v[100:103], v[236:239], v[24:27]
    s_setprio 0
    s_waitcnt lgkmcnt(1)
    v_mfma_f32_16x16x32_bf16 v[24:27], v[104:107], v[200:203], v[24:27]
    v_mfma_f32_16x16x32_bf16 v[32:35], v[56:59], v[108:111], v[32:35]
    v_mfma_f32_16x16x32_bf16 v[32:35], v[60:63], v[112:115], v[32:35]
    v_mfma_f32_16x16x32_bf16 v[36:39], v[56:59], v[116:119], v[36:39]
    ds_read_b128 v[124:127], v4 offset:2624
    v_mfma_f32_16x16x32_bf16 v[36:39], v[60:63], v[120:123], v[36:39]
    s_nop 2
    v_cvt_pk_bf16_f32 v24, v24, v25
    v_cvt_pk_bf16_f32 v25, v26, v27
    ds_write_b64 v68, v[24:25] offset:5504
    s_waitcnt lgkmcnt(0)
    s_barrier
    s_sub_u32 s42, s3, 3
    s_cmp_le_u32 s42, 1
    s_cbranch_scc1 L_b_out4
L_b_back4:
    s_setprio 3
    v_mfma_f32_16x16x32_bf16 v[40:43], v[220:223], v[180:183], 0
    ds_read_b128 v[128:131], v4 offset:2688
    v_mfma_f32_16x16x32_bf16 v[44:47], v[220:223], v[184:187], 0
    v_mfma_f32_16x16x32_bf16 v[48:51], v[220:223], v[188:191], 0
    ds_read_b128 v[132:135], v4 offset:2752
    v_mfma_f32_16x16x32_bf16 v[52:55], v[220:223], v[192:195], 0
    v_mfma_f32_16x16x32_bf16 v[28:31], v[148:151], v[140:143], v[28:31]
    ds_read_b128 v[20:23], v4 offset:2816
    v_mfma_f32_16x16x32_bf16 v[28:31], v[72:75], v[124:127], v[28:31]
    v_mfma_f32_16x16x32_bf16 v[28:31], v[152:155], v[12:15], v[28:31]
    ds_read_b128 v[244:247], v4 offset:2880
    s_waitcnt lgkmcnt(3)
    v_mfma_f32_16x16x32_bf16 v[28:31], v[76:79], v[128:131], v[28:31]
    v_mfma_f32_16x16x32_bf16 v[28:31], v[156:159], v[204:207], v[28:31]
    v_cvt_pk_bf16_f32 v56, v40, v44
    ds_read_b128 v[224:227], v4 offset:2944
    s_waitcnt lgkmcnt(3)
    v_mfma_f32_16x16x32_bf16 v[28:31], v[80:83], v[132:135], v[28:31]
    v_cvt_pk_bf16_f32 v57, v48, v52
    v_mfma_f32_16x16x32_bf16 v[28:31], v[160:163], v[144:147], v[28:31]
    v_cvt_pk_bf16_f32 v58, v41, v45
    ds_read_b128 v[240:243], v4 offset:3008
    s_waitcnt lgkmcnt(3)
    v_mfma_f32_16x16x32_bf16 v[28:31], v[84:87], v[20:23], v[28:31]
    v_cvt_pk_bf16_f32 v59, v49, v53
    ds_read_b128 v[232:235], v4 offset:1024
    v_mfma_f32_16x16x32_bf16 v[28:31], v[164:167], v[208:211], v[28:31]
    v_cvt_pk_bf16_f32 v60, v42, v46
    s_waitcnt lgkmcnt(3)
    v_mfma_f32_16x16x32_bf16 v[28:31], v[88:91], v[244:247], v[28:31]
    v_cvt_pk_bf16_f32 v61, v50, v54
    v_mfma_f32_16x16x32_bf16 v[28:31], v[168:171], v[252:255], v[28:31]
    v_cvt_pk_bf16_f32 v62, v43, v47
    ds_read_b128 v[216:219], v4 offset:3072
    s_waitcnt lgkmcnt(3)
    v_mfma_f32_16x16x32_bf16 v[28:31], v[92:95], v[224:227], v[28:31]
    v_cvt_pk_bf16_f32 v63, v51, v55
    v_mfma_f32_16x16x32_bf16 v[28:31], v[172:175], v[228:231], v[28:31]
    s_waitcnt lgkmcnt(1)
    v_mfma_f32_16x16x32_bf16 v[28:31], v[96:99], v[240:243], v[28:31]
    s_setprio 2
    v_mfma_f32_16x16x32_bf16 v[28:31], v[8:11], v[232:235], v[28:31]
    ds_read_b128 v[136:139], v4 offset:3136
    v_mfma_f32_16x16x32_bf16 v[28:31], v[176:179], v[236:239], v[28:31]
    v_mfma_f32_16x16x32_bf16 v[28:31], v[100:103], v[200:203], v[28:31]
    ds_read_b128 v[16:19], v4 offset:3200
    s_waitcnt lgkmcnt(2)
    v_mfma_f32_16x16x32_bf16 v[28:31], v[104:107], v[216:219], v[28:31]
    v_mfma_f32_16x16x32_bf16 v[36:39], v[56:59], v[108:111], v[36:39]
    ds_read_b128 v[248:251], v4 offset:3264
    v_mfma_f32_16x16x32_bf16 v[36:39], v[60:63], v[112:115], v[36:39]
    s_nop 4
    v_cvt_pk_bf16_f32 v28, v28, v29
    v_cvt_pk_bf16_f32 v29, v30, v31
    ds_write_b64 v68, v[28:29] offset:6016
    v_mfma_f32_16x16x32_bf16 v[32:35], v[148:151], v[124:127], v[32:35]
    ds_read_b128 v[196:199], v4 offset:3328
    s_waitcnt lgkmcnt(4)
    v_mfma_f32_16x16x32_bf16 v[32:35], v[72:75], v[136:139], v[32:35]
    v_mfma_f32_16x16x32_bf16 v[32:35], v[152:155], v[128:131], v[32:35]
    ds_read_b128 v[116:119], v4 offset:3392
    s_waitcnt lgkmcnt(4)
    v_mfma_f32_16x16x32_bf16 v[32:35], v[76:79], v[16:19], v[32:35]
    v_mfma_f32_16x16x32_bf16 v[32:35], v[156:159], v[132:135], v[32:35]
    ds_read_b128 v[120:123], v4 offset:3456
    s_waitcnt lgkmcnt(3)
    v_mfma_f32_16x16x32_bf16 v[32:35], v[80:83], v[248:251], v[32:35]
    v_mfma_f32_16x16x32_bf16 v[32:35], v[160:163], v[20:23], v[32:35]
    s_setprio 1
    ds_read_b128 v[24:27], v4 offset:3520
    s_waitcnt lgkmcnt(3)
    v_mfma_f32_16x16x32_bf16 v[32:35], v[84:87], v[196:199], v[32:35]
    v_mfma_f32_16x16x32_bf16 v[32:35], v[164:167], v[244:247], v[32:35]
    s_waitcnt lgkmcnt(2)
    v_mfma_f32_16x16x32_bf16 v[32:35], v[88:91], v[116:119], v[32:35]
    v_mfma_f32_16x16x32_bf16 v[32:35], v[168:171], v[224:227], v[32:35]
    ds_read_b128 v[180:183], v4 offset:3584
    s_waitcnt lgkmcnt(2)
    v_mfma_f32_16x16x32_bf16 v[32:35], v[92:95], v[120:123], v[32:35]
    v_mfma_f32_16x16x32_bf16 v[32:35], v[172:175], v[240:243], v[32:35]
    ds_read_b128 v[184:187], v4 offset:3648
    s_waitcnt lgkmcnt(2)
    v_mfma_f32_16x16x32_bf16 v[32:35], v[96:99], v[24:27], v[32:35]
    s_setprio 0
    v_mfma_f32_16x16x32_bf16 v[32:35], v[8:11], v[212:215], v[32:35]
    ds_read_b128 v[188:191], v4 offset:3712
    v_mfma_f32_16x16x32_bf16 v[32:35], v[176:179], v[200:203], v[32:35]
    v_mfma_f32_16x16x32_bf16 v[32:35], v[100:103], v[216:219], v[32:35]
    ds_read_b128 v[192:195], v4 offset:3776
    s_waitcnt lgkmcnt(3)
    v_mfma_f32_16x16x32_bf16 v[32:35], v[104:107], v[180:183], v[32:35]
    s_nop 7
    v_cvt_pk_bf16_f32 v32, v32, v33
    v_cvt_pk_bf16_f32 v33, v34, v35
    ds_write_b64 v68, v[32:33] offset:6528
    s_waitcnt lgkmcnt(0)
    s_barrier
    s_sub_u32 s42, s3, 5
    s_cmp_le_u32 s42, 1
    s_cbranch_scc1 L_b_out6
L_b_back6:
    s_setprio 3
    v_mfma_f32_16x16x32_bf16 v[36:39], v[148:151], v[136:139], v[36:39]
    ds_read_b128 v[220:223], v4 offset:3840
    v_mfma_f32_16x16x32_bf16 v[36:39], v[72:75], v[184:187], v[36:39]
    v_mfma_f32_16x16x32_bf16 v[36:39], v[152:155], v[16:19], v[36:39]
    ds_read_b128 v[140:143], v4 offset:3904
    v_mfma_f32_16x16x32_bf16 v[36:39], v[76:79], v[188:191], v[36:39]
    v_mfma_f32_16x16x32_bf16 v[36:39], v[156:159], v[248:251], v[36:39]
    ds_read_b128 v[12:15], v4 offset:3968
    v_mfma_f32_16x16x32_bf16 v[36:39], v[80:83], v[192:195], v[36:39]
    v_mfma_f32_16x16x32_bf16 v[36:39], v[160:163], v[196:199], v[36:39]
    ds_read_b128 v[204:207], v4 offset:4032
    s_waitcnt lgkmcnt(3)
    v_mfma_f32_16x16x32_bf16 v[36:39], v[84:87], v[220:223], v[36:39]
    s_setprio 2
    v_mfma_f32_16x16x32_bf16 v[36:39], v[164:167], v[116:119], v[36:39]
    s_waitcnt lgkmcnt(2)
    v_mfma_f32_16x16x32_bf16 v[36:39], v[88:91], v[140:143], v[36:39]
    v_mfma_f32_16x16x32_bf16 v[36:39], v[168:171], v[120:123], v[36:39]
    ds_read_b128 v[144:147], v4 offset:4096
    s_waitcnt lgkmcnt(2)
    v_mfma_f32_16x16x32_bf16 v[36:39], v[92:95], v[12:15], v[36:39]
    v_mfma_f32_16x16x32_bf16 v[36:39], v[172:175], v[24:27], v[36:39]
    s_setprio 1
    s_waitcnt lgkmcnt(1)
    v_mfma_f32_16x16x32_bf16 v[36:39], v[96:99], v[204:207], v[36:39]
    v_mfma_f32_16x16x32_bf16 v[36:39], v[8:11], v[236:239], v[36:39]
    v_mfma_f32_16x16x32_bf16 v[36:39], v[176:179], v[216:219], v[36:39]
    s_setprio 0
    v_mfma_f32_16x16x32_bf16 v[36:39], v[100:103], v[180:183], v[36:39]
    s_waitcnt lgkmcnt(0)
    v_mfma_f32_16x16x32_bf16 v[36:39], v[104:107], v[144:147], v[36:39]
    s_nop 7
    v_cvt_pk_bf16_f32 v36, v36, v37
    v_cvt_pk_bf16_f32 v37, v38, v39
    ds_write_b64 v68, v[36:37] offset:7040
    s_waitcnt lgkmcnt(0)
    s_barrier
    s_sub_u32 s42, s3, 7
    s_cmp_le_u32 s42, 0
    s_cbranch_scc1 L_b_out7
L_b_back7:
    s_endpgm
L_b_side0:
    s_add_u32 s37, s38, 640
L_b_pf1:
    s_mov_b64 exec, s[68:69]
    s_add_u32 s36, s38, s67
    buffer_load_dword v31, v160, s[72:75], s38 offen
    buffer_load_dword v31, v160, s[72:75], s36 offen
    s_add_u32 s36, s36, s67
    s_mul_i32 s39, s38, 1920
    buffer_load_dword v31, v160, s[72:75], s36 offen
    s_mov_b64 exec, s[70:71]
    s_add_u32 s36, s39, s61
    buffer_load_dword v31, v162, s[76:79], s39 offen
    buffer_load_dword v31, v162, s[76:79], s36 offen
    s_addk_i32 s38, 128
    s_cmp_lt_u32 s38, s37
    s_cbranch_scc1 L_b_pf1
    s_mov_b64 exec, -1
    s_branch L_b_sb0
L_b_side1:
    s_cmp_eq_u32 s101, 0
    s_cbranch_scc1 L_b_nowo
    s_lshr_b32 s36, s4, 1
    s_mul_i32 s36, s36, 12
    s_add_u32 s36, s36, s5
    s_mul_i32 s36, s36, 135
    v_add_u32 v163, s36, v1
    v_min_u32 v163, 6309, v163
    v_lshlrev_b32_e64 v163, 7, v163
    s_mov_b32 exec_hi, 0x1fff
    global_load_dword v31, v163, s[14:15]
    v_add_u32 v163, 5760, v163
    global_load_dword v31, v163, s[14:15]
    v_add_u32 v163, 5760, v163
    global_load_dword v31, v163, s[14:15]
    s_mov_b64 exec, -1
L_b_nowo:
    v_lshrrev_b32 v161, s101, v1
    v_mul_u32_u24 v161, 1280, v161
    v_and_b32_e64 v160, s101, v1
    v_lshl_add_u32 v160, v160, 7, v161
    s_cmp_lg_u32 s101, 0
    s_cselect_b32 s67, 29, 43
    s_lshl_b32 s36, s67, s101
    s_bfm_b64 exec, s36, 0
    s_mul_i32 s67, s67, 1280
    s_mul_i32 s36, s5, s67
    s_mul_i32 s36, s36, 6
    s_lshl_b32 s37, s7, 4
    s_and_b32 s37, s37, 0xff80
    s_add_u32 s36, s36, s37
    buffer_load_dword v31, v160, s[48:51], s36 offen
    s_add_u32 s36, s36, s67
    buffer_load_dword v31, v160, s[48:51], s36 offen
    s_add_u32 s36, s36, s67
    buffer_load_dword v31, v160, s[48:51], s36 offen
    s_add_u32 s36, s36, s67
    buffer_load_dword v31, v160, s[48:51], s36 offen
    s_add_u32 s36, s36, s67
    buffer_load_dword v31, v160, s[48:51], s36 offen
    s_add_u32 s36, s36, s67
    buffer_load_dword v31, v160, s[48:51], s36 offen
    s_add_u32 s36, s36, s67
    s_mov_b64 exec, -1
    s_branch L_b_sb1
L_b_out2:
    ds_read_b64 v[40:41], v69 offset:3456
    ds_read_b64 v[42:43], v69 offset:11648
    ds_read_b64 v[44:45], v69 offset:19840
    ds_read_b64 v[46:47], v69 offset:28032
    ds_read_b64 v[48:49], v69 offset:36224
    ds_read_b64 v[50:51], v69 offset:44416
    ds_read_b64 v[52:53], v69 offset:52608
    ds_read_b64 v[54:55], v69 offset:60800
    s_waitcnt lgkmcnt(6)
    v_perm_b32 v56, v42, v40, s62
    s_waitcnt lgkmcnt(4)
    v_perm_b32 v57, v46, v44, s62
    s_waitcnt lgkmcnt(2)
    v_perm_b32 v58, v50, v48, s62
    s_waitcnt lgkmcnt(0)
    v_perm_b32 v59, v54, v52, s62
    global_store_dwordx4 v70, v[56:59], s[30:31] offset:-2560
    v_perm_b32 v60, v42, v40, s63
    v_perm_b32 v61, v46, v44, s63
    v_perm_b32 v62, v50, v48, s63
    v_perm_b32 v63, v54, v52, s63
    global_store_dwordx4 v70, v[60:63], s[30:31] offset:0
    v_perm_b32 v64, v43, v41, s62
    v_perm_b32 v65, v47, v45, s62
    v_perm_b32 v66, v51, v49, s62
    v_perm_b32 v67, v55, v53, s62
    global_store_dwordx4 v71, v[64:67], s[30:31] offset:-2560
    v_perm_b32 v56, v43, v41, s63
    v_perm_b32 v57, v47, v45, s63
    v_perm_b32 v58, v51, v49, s63
    v_perm_b32 v59, v55, v53, s63
    global_store_dwordx4 v71, v[56:59], s[30:31] offset:0
    s_branch L_b_back2
    s_nop 0
L_b_out4:
    ds_read_b64 v[40:41], v69 offset:3456
    ds_read_b64 v[42:43], v69 offset:11648
    ds_read_b64 v[44:45], v69 offset:19840
    ds_read_b64 v[46:47], v69 offset:28032
    ds_read_b64 v[48:49], v69 offset:36224
    ds_read_b64 v[50:51], v69 offset:44416
    ds_read_b64 v[52:53], v69 offset:52608
    ds_read_b64 v[54:55], v69 offset:60800
    s_waitcnt lgkmcnt(6)
    v_perm_b32 v56, v42, v40, s62
    s_waitcnt lgkmcnt(4)
    v_perm_b32 v57, v46, v44, s62
    s_waitcnt lgkmcnt(2)
    v_perm_b32 v58, v50, v48, s62
    s_waitcnt lgkmcnt(0)
    v_perm_b32 v59, v54, v52, s62
    global_store_dwordx4 v70, v[56:59], s[30:31] offset:-2560
    v_perm_b32 v60, v42, v40, s63
    v_perm_b32 v61, v46, v44, s63
    v_perm_b32 v62, v50, v48, s63
    v_perm_b32 v63, v54, v52, s63
    global_store_dwordx4 v70, v[60:63], s[30:31] offset:0
    v_perm_b32 v64, v43, v41, s62
    v_perm_b32 v65, v47, v45, s62
    v_perm_b32 v66, v51, v49, s62
    v_perm_b32 v67, v55, v53, s62
    global_store_dwordx4 v71, v[64:67], s[30:31] offset:-2560
    v_perm_b32 v56, v43, v41, s63
    v_perm_b32 v57, v47, v45, s63
    v_perm_b32 v58, v51, v49, s63
    v_perm_b32 v59, v55, v53, s63
    global_store_dwordx4 v71, v[56:59], s[30:31] offset:0
    s_branch L_b_back4
    s_nop 0
L_b_out6:
    ds_read_b64 v[40:41], v69 offset:3456
    ds_read_b64 v[42:43], v69 offset:11648
    ds_read_b64 v[44:45], v69 offset:19840
    ds_read_b64 v[46:47], v69 offset:28032
    ds_read_b64 v[48:49], v69 offset:36224
    ds_read_b64 v[50:51], v69 offset:44416
    ds_read_b64 v[52:53], v69 offset:52608
    ds_read_b64 v[54:55], v69 offset:60800
    s_waitcnt lgkmcnt(6)
    v_perm_b32 v56, v42, v40, s62
    s_waitcnt lgkmcnt(4)
    v_perm_b32 v57, v46, v44, s62
    s_waitcnt lgkmcnt(2)
    v_perm_b32 v58, v50, v48, s62
    s_waitcnt lgkmcnt(0)
    v_perm_b32 v59, v54, v52, s62
    global_store_dwordx4 v70, v[56:59], s[30:31] offset:-2560
    v_perm_b32 v60, v42, v40, s63
    v_perm_b32 v61, v46, v44, s63
    v_perm_b32 v62, v50, v48, s63
    v_perm_b32 v63, v54, v52, s63
    global_store_dwordx4 v70, v[60:63], s[30:31] offset:0
    v_perm_b32 v64, v43, v41, s62
    v_perm_b32 v65, v47, v45, s62
    v_perm_b32 v66, v51, v49, s62
    v_perm_b32 v67, v55, v53, s62
    global_store_dwordx4 v71, v[64:67], s[30:31] offset:-2560
    v_perm_b32 v56, v43, v41, s63
    v_perm_b32 v57, v47, v45, s63
    v_perm_b32 v58, v51, v49, s63
    v_perm_b32 v59, v55, v53, s63
    global_store_dwordx4 v71, v[56:59], s[30:31] offset:0
    s_branch L_b_back6
    s_nop 0
L_b_out7:
    ds_read_b64 v[40:41], v69 offset:3456
    ds_read_b64 v[42:43], v69 offset:11648
    ds_read_b64 v[44:45], v69 offset:19840
    ds_read_b64 v[46:47], v69 offset:28032
    ds_read_b64 v[48:49], v69 offset:36224
    ds_read_b64 v[50:51], v69 offset:44416
    ds_read_b64 v[52:53], v69 offset:52608
    ds_read_b64 v[54:55], v69 offset:60800
    s_waitcnt lgkmcnt(6)
    v_perm_b32 v56, v42, v40, s62
    s_waitcnt lgkmcnt(4)
    v_perm_b32 v57, v46, v44, s62
    s_waitcnt lgkmcnt(2)
    v_perm_b32 v58, v50, v48, s62
    s_waitcnt lgkmcnt(0)
    v_perm_b32 v59, v54, v52, s62
    global_store_dwordx4 v70, v[56:59], s[30:31] offset:-2560
    v_perm_b32 v60, v42, v40, s63
    v_perm_b32 v61, v46, v44, s63
    v_perm_b32 v62, v50, v48, s63
    v_perm_b32 v63, v54, v52, s63
    global_store_dwordx4 v70, v[60:63], s[30:31] offset:0
    v_perm_b32 v64, v43, v41, s62
    v_perm_b32 v65, v47, v45, s62
    v_perm_b32 v66, v51, v49, s62
    v_perm_b32 v67, v55, v53, s62
    global_store_dwordx4 v71, v[64:67], s[30:31] offset:-2560
    v_perm_b32 v56, v43, v41, s63
    v_perm_b32 v57, v47, v45, s63
    v_perm_b32 v58, v51, v49, s63
    v_perm_b32 v59, v55, v53, s63
    global_store_dwordx4 v71, v[56:59], s[30:31] offset:0
    s_branch L_b_back7
    s_nop 0
L_end:
    s_endpgm
.section .rodata,"a"
.p2align 6
.amdhsa_kernel concat_heads__linear_kernel_hedgehog__ssm_conv_s4d__prompt_kernel
  .amdhsa_next_free_vgpr 256
  .amdhsa_next_free_sgpr 102
  .amdhsa_accum_offset 256
  .amdhsa_group_segment_fixed_size 0
  .amdhsa_kernarg_size 112
  .amdhsa_user_sgpr_count 2
  .amdhsa_user_sgpr_kernarg_segment_ptr 1
  .amdhsa_system_sgpr_workgroup_id_x 1
.end_amdhsa_kernel
```
